```python
import torch

def _softmax(x, axis=-1):
    return torch.softmax(x, dim=axis)
def _gelu(x):
    return torch.nn.functional.gelu(x, approximate="tanh")
def _silu(x):
    return torch.nn.functional.silu(x)
def _sigmoid(x):
    return torch.sigmoid(x)
def _layernorm(x, axis=-1, eps=1e-5):
    m = x.mean(dim=axis, keepdim=True)
    v = x.var(dim=axis, keepdim=True, unbiased=False)
    return (x - m) / torch.sqrt(v + eps)
def _scatter_add(tgt, idx, src, axis=0):
    return tgt.clone().index_add_(axis, idx, src)
def _segment_sum(src, seg, n):
    out = torch.zeros((n,) + src.shape[1:], dtype=src.dtype)
    return out.index_add_(0, seg, src)
def _pad(x, pw):
    flat = tuple(v for pair in reversed(pw) for v in pair)
    return torch.nn.functional.pad(x, flat)

kernel_name = 'standalone__gqa_block_cached__decode'

def setup_inputs():

    _w = (lambda a: (lambda t: t.to(torch.bfloat16) if t.is_floating_point() else t)(torch.as_tensor(a)))
    B, Sq, D = 2, 1, 576
    Hq, Hkv, Sk, Dh = 32, 16, 32768, 128
    assert Hq % Hkv == 0, (Hq, Hkv)
    return {
        "x": _w((lambda *s: torch.randn(*s, dtype=torch.bfloat16) * 0.8)(B, Sq, D)),
        "k_cache": _w((lambda *s: torch.randn(*s, dtype=torch.bfloat16) * 0.8)(B, Hkv, Sk, Dh)),
        "v_cache": _w((lambda *s: torch.randn(*s, dtype=torch.bfloat16) * 0.05)(B, Hkv, Sk, Dh)),
        "wq": _w((lambda *s: torch.randn(*s, dtype=torch.bfloat16) * 0.8)(D, Hq * Dh) * (D ** -0.5)),
        "wo": _w((lambda *s: torch.randn(*s, dtype=torch.bfloat16) * 0.05)(Hq * Dh, D) * ((Hq * Dh) ** -0.5)),
    }

def reference(x, k_cache, v_cache, wq, wo):
    B, Sq, D = x.shape
    Hq, Dh = 32, 128
    Hkv = k_cache.shape[1]
    rep = Hq // Hkv
    q = (lambda x, *d: x.permute(*d))((x @ wq).reshape(B, Sq, Hq, Dh), 0, 2, 1, 3)
    k = (lambda x, n, axis: torch.repeat_interleave(x, n, dim=axis))(k_cache, rep, axis=1)
    v = (lambda x, n, axis: torch.repeat_interleave(x, n, dim=axis))(v_cache, rep, axis=1)
    scores = torch.einsum("bhqd,bhkd->bhqk", q, k) * (Dh ** -0.5)
    p = _softmax(scores, axis=-1)
    o = torch.einsum("bhqk,bhkd->bhqd", p, v)
    return (lambda x, *d: x.permute(*d))(o, 0, 2, 1, 3).reshape(B, Sq, Hq * Dh) @ wo
```

```asm
; @launch grid=(256,1,1) block=(320,1,1) lds=13312
.amdgcn_target "amdgcn-amd-amdhsa--gfx950"
.text
.globl standalone__gqa_block_cached__decode_kernel
.p2align 8
.type standalone__gqa_block_cached__decode_kernel,@function
standalone__gqa_block_cached__decode_kernel:
    s_cmp_ge_u32 s2, 256
    s_cbranch_scc1 L_done
    s_load_dwordx16 s[4:19], s[0:1], 0
    v_and_b32 v1, 63, v0
    v_lshrrev_b32 v27, 6, v0
    v_lshlrev_b32 v2, 4, v1
    v_readfirstlane_b32 s20, v27
    v_mov_b32 v31, 0x40000000
    v_cmp_eq_u32 vcc, 0, v1
    s_nop 1
    v_cndmask_b32 v31, v31, 0, vcc
    s_lshr_b32 s21, s2, 4
    s_bfe_u32 s22, s2, 0x10003
    s_and_b32 s23, s2, 7
    s_lshl_b32 s24, s22, 4
    s_add_u32 s24, s24, s21
    s_lshl_b32 s44, s24, 8
    s_add_u32 s44, s44, 3145728
    s_mul_i32 s45, s24, 0
    s_lshl_b32 s24, s24, 23
    s_mov_b32 s30, 0x3e0293ee
    v_and_b32 v27, 1, v1
    v_lshlrev_b32 v27, 4, v27
    v_mov_b32 v28, 0xffff
    v_lshlrev_b32 v27, v27, v28
    v_bfe_u32 v28, v1, 1, 2
    v_cmp_eq_u32 vcc, 0, v28
    s_nop 1
    v_cndmask_b32 v16, 0, v27, vcc
    v_cmp_eq_u32 vcc, 1, v28
    s_nop 1
    v_cndmask_b32 v17, 0, v27, vcc
    v_cmp_eq_u32 vcc, 2, v28
    s_nop 1
    v_cndmask_b32 v18, 0, v27, vcc
    v_cmp_eq_u32 vcc, 3, v28
    s_nop 1
    v_cndmask_b32 v19, 0, v27, vcc
    s_cmp_eq_u32 s20, 0
    s_nop 0
    s_cbranch_scc1 L_helper
    s_mul_i32 s25, s23, 4
    s_add_u32 s25, s25, s20
    s_sub_u32 s25, s25, 1
    s_add_u32 s26, s25, 0
    s_add_u32 s29, s26, s45
    s_and_b32 s29, s29, 2047
    s_bfe_u32 s31, s29, 0x20004
    s_lshl_b32 s31, s31, 9
    s_lshr_b32 s28, s29, 6
    s_lshl_b32 s28, s28, 4
    s_or_b32 s31, s31, s28
    s_and_b32 s29, s29, 15
    s_or_b32 s29, s29, s31
    s_lshl_b32 s29, s29, 12
    s_add_u32 s29, s29, s24
    s_cmp_lt_u32 s26, 2048
    s_cselect_b32 s80, s29, 0x10000000
    s_add_u32 s26, s25, 32
    s_add_u32 s29, s26, s45
    s_and_b32 s29, s29, 2047
    s_bfe_u32 s31, s29, 0x20004
    s_lshl_b32 s31, s31, 9
    s_lshr_b32 s28, s29, 6
    s_lshl_b32 s28, s28, 4
    s_or_b32 s31, s31, s28
    s_and_b32 s29, s29, 15
    s_or_b32 s29, s29, s31
    s_lshl_b32 s29, s29, 12
    s_add_u32 s29, s29, s24
    s_cmp_lt_u32 s26, 2048
    s_cselect_b32 s81, s29, 0x10000000
    s_add_u32 s26, s25, 64
    s_add_u32 s29, s26, s45
    s_and_b32 s29, s29, 2047
    s_bfe_u32 s31, s29, 0x20004
    s_lshl_b32 s31, s31, 9
    s_lshr_b32 s28, s29, 6
    s_lshl_b32 s28, s28, 4
    s_or_b32 s31, s31, s28
    s_and_b32 s29, s29, 15
    s_or_b32 s29, s29, s31
    s_lshl_b32 s29, s29, 12
    s_add_u32 s29, s29, s24
    s_cmp_lt_u32 s26, 2048
    s_cselect_b32 s82, s29, 0x10000000
    s_add_u32 s26, s25, 96
    s_add_u32 s29, s26, s45
    s_and_b32 s29, s29, 2047
    s_bfe_u32 s31, s29, 0x20004
    s_lshl_b32 s31, s31, 9
    s_lshr_b32 s28, s29, 6
    s_lshl_b32 s28, s28, 4
    s_or_b32 s31, s31, s28
    s_and_b32 s29, s29, 15
    s_or_b32 s29, s29, s31
    s_lshl_b32 s29, s29, 12
    s_add_u32 s29, s29, s24
    s_cmp_lt_u32 s26, 2048
    s_cselect_b32 s83, s29, 0x10000000
    s_add_u32 s26, s25, 128
    s_add_u32 s29, s26, s45
    s_and_b32 s29, s29, 2047
    s_bfe_u32 s31, s29, 0x20004
    s_lshl_b32 s31, s31, 9
    s_lshr_b32 s28, s29, 6
    s_lshl_b32 s28, s28, 4
    s_or_b32 s31, s31, s28
    s_and_b32 s29, s29, 15
    s_or_b32 s29, s29, s31
    s_lshl_b32 s29, s29, 12
    s_add_u32 s29, s29, s24
    s_cmp_lt_u32 s26, 2048
    s_cselect_b32 s84, s29, 0x10000000
    s_add_u32 s26, s25, 160
    v_mov_b32 v52, s26
    v_and_b32 v27, 15, v1
    v_lshlrev_b32 v27, 4, v27
    v_bfe_u32 v28, v1, 3, 1
    v_lshl_add_u32 v27, v28, 8, v27
    v_xor_b32 v28, 0x100, v27
    v_mov_b32 v24, 0xff800000
    v_mov_b32 v25, 0
    v_mov_b32 v20, 0
    v_mov_b32 v21, 0
    v_mov_b32 v22, 0
    v_mov_b32 v23, 0
    v_mov_b32 v61, 0x40000000
    s_waitcnt lgkmcnt(0)
    s_mov_b32 s32, s6
    s_and_b32 s33, s7, 0xffff
    s_mov_b32 s34, 0x10000000
    s_mov_b32 s35, 0x00020000
    s_mov_b32 s36, s8
    s_and_b32 s37, s9, 0xffff
    s_mov_b32 s38, 0x10000000
    s_mov_b32 s39, 0x00020000
    s_mov_b32 s40, s18
    s_and_b32 s41, s19, 0xffff
    s_mov_b32 s42, 0x40000000
    s_mov_b32 s43, 0x00020000
    s_mov_b32 s56, s12
    s_and_b32 s57, s13, 0xffff
    s_mov_b32 s58, 0x480000
    s_mov_b32 s59, 0x00020000
    s_barrier
    buffer_load_dword v60, v61, s[40:43], 0 offen
    buffer_load_dwordx4 v[64:67], v2, s[32:35], s80 offen offset:0 nt
    buffer_load_dwordx4 v[68:71], v2, s[32:35], s80 offen offset:1024 nt
    buffer_load_dwordx4 v[72:75], v2, s[32:35], s80 offen offset:2048 nt
    buffer_load_dwordx4 v[76:79], v2, s[32:35], s80 offen offset:3072 nt
    buffer_load_dwordx4 v[80:83], v2, s[36:39], s80 offen offset:0 nt
    buffer_load_dwordx4 v[84:87], v2, s[36:39], s80 offen offset:1024 nt
    buffer_load_dwordx4 v[88:91], v2, s[36:39], s80 offen offset:2048 nt
    buffer_load_dwordx4 v[92:95], v2, s[36:39], s80 offen offset:3072 nt
    s_waitcnt vmcnt(0)
    buffer_load_dwordx4 v[96:99], v2, s[32:35], s81 offen offset:0 nt
    buffer_load_dwordx4 v[100:103], v2, s[32:35], s81 offen offset:1024 nt
    buffer_load_dwordx4 v[104:107], v2, s[32:35], s81 offen offset:2048 nt
    buffer_load_dwordx4 v[108:111], v2, s[32:35], s81 offen offset:3072 nt
    buffer_load_dwordx4 v[112:115], v2, s[36:39], s81 offen offset:0 nt
    buffer_load_dwordx4 v[116:119], v2, s[36:39], s81 offen offset:1024 nt
    buffer_load_dwordx4 v[120:123], v2, s[36:39], s81 offen offset:2048 nt
    buffer_load_dwordx4 v[124:127], v2, s[36:39], s81 offen offset:3072 nt
    s_waitcnt vmcnt(0)
    buffer_load_dwordx4 v[128:131], v2, s[32:35], s82 offen offset:0 nt
    buffer_load_dwordx4 v[132:135], v2, s[32:35], s82 offen offset:1024 nt
    buffer_load_dwordx4 v[136:139], v2, s[32:35], s82 offen offset:2048 nt
    buffer_load_dwordx4 v[140:143], v2, s[32:35], s82 offen offset:3072 nt
    buffer_load_dwordx4 v[144:147], v2, s[36:39], s82 offen offset:0 nt
    buffer_load_dwordx4 v[148:151], v2, s[36:39], s82 offen offset:1024 nt
    buffer_load_dwordx4 v[152:155], v2, s[36:39], s82 offen offset:2048 nt
    buffer_load_dwordx4 v[156:159], v2, s[36:39], s82 offen offset:3072 nt
    s_waitcnt vmcnt(0)
    buffer_load_dwordx4 v[160:163], v2, s[32:35], s83 offen offset:0 nt
    buffer_load_dwordx4 v[164:167], v2, s[32:35], s83 offen offset:1024 nt
    buffer_load_dwordx4 v[168:171], v2, s[32:35], s83 offen offset:2048 nt
    buffer_load_dwordx4 v[172:175], v2, s[32:35], s83 offen offset:3072 nt
    buffer_load_dwordx4 v[176:179], v2, s[36:39], s83 offen offset:0 nt
    buffer_load_dwordx4 v[180:183], v2, s[36:39], s83 offen offset:1024 nt
    buffer_load_dwordx4 v[184:187], v2, s[36:39], s83 offen offset:2048 nt
    buffer_load_dwordx4 v[188:191], v2, s[36:39], s83 offen offset:3072 nt
    s_waitcnt vmcnt(0)
    buffer_load_dwordx4 v[192:195], v2, s[32:35], s84 offen offset:0 nt
    buffer_load_dwordx4 v[196:199], v2, s[32:35], s84 offen offset:1024 nt
    buffer_load_dwordx4 v[200:203], v2, s[32:35], s84 offen offset:2048 nt
    buffer_load_dwordx4 v[204:207], v2, s[32:35], s84 offen offset:3072 nt
    buffer_load_dwordx4 v[208:211], v2, s[36:39], s84 offen offset:0 nt
    buffer_load_dwordx4 v[212:215], v2, s[36:39], s84 offen offset:1024 nt
    buffer_load_dwordx4 v[216:219], v2, s[36:39], s84 offen offset:2048 nt
    buffer_load_dwordx4 v[220:223], v2, s[36:39], s84 offen offset:3072 nt
    s_barrier
    ds_read_b128 v[8:11], v27 offset:0
    ds_read_b128 v[12:15], v28 offset:0
    s_waitcnt lgkmcnt(0)
    v_readfirstlane_b32 s26, v52
    v_dot2_f32_bf16 v32, v64, v8, 0
    v_dot2_f32_bf16 v40, v64, v12, 0
    v_dot2_f32_bf16 v32, v65, v9, v32
    v_dot2_f32_bf16 v40, v65, v13, v40
    v_dot2_f32_bf16 v32, v66, v10, v32
    v_dot2_f32_bf16 v40, v66, v14, v40
    v_dot2_f32_bf16 v32, v67, v11, v32
    v_dot2_f32_bf16 v40, v67, v15, v40
    v_dot2_f32_bf16 v33, v68, v8, 0
    v_dot2_f32_bf16 v41, v68, v12, 0
    v_dot2_f32_bf16 v33, v69, v9, v33
    v_dot2_f32_bf16 v41, v69, v13, v41
    v_dot2_f32_bf16 v33, v70, v10, v33
    v_dot2_f32_bf16 v41, v70, v14, v41
    v_dot2_f32_bf16 v33, v71, v11, v33
    v_dot2_f32_bf16 v41, v71, v15, v41
    v_dot2_f32_bf16 v34, v72, v8, 0
    v_dot2_f32_bf16 v42, v72, v12, 0
    v_dot2_f32_bf16 v34, v73, v9, v34
    v_dot2_f32_bf16 v42, v73, v13, v42
    v_dot2_f32_bf16 v34, v74, v10, v34
    v_dot2_f32_bf16 v42, v74, v14, v42
    v_dot2_f32_bf16 v34, v75, v11, v34
    v_dot2_f32_bf16 v42, v75, v15, v42
    v_dot2_f32_bf16 v35, v76, v8, 0
    v_dot2_f32_bf16 v43, v76, v12, 0
    v_dot2_f32_bf16 v35, v77, v9, v35
    v_dot2_f32_bf16 v43, v77, v13, v43
    v_dot2_f32_bf16 v35, v78, v10, v35
    v_dot2_f32_bf16 v43, v78, v14, v43
    v_dot2_f32_bf16 v35, v79, v11, v35
    v_dot2_f32_bf16 v43, v79, v15, v43
    v_add_f32_dpp v32, v40, v32 row_ror:8 row_mask:0xf bank_mask:0xf
    v_add_f32_dpp v33, v41, v33 row_ror:8 row_mask:0xf bank_mask:0xf
    v_add_f32_dpp v34, v42, v34 row_ror:8 row_mask:0xf bank_mask:0xf
    v_add_f32_dpp v35, v43, v35 row_ror:8 row_mask:0xf bank_mask:0xf
    v_add_f32_dpp v32, v32, v32 row_half_mirror row_mask:0xf bank_mask:0xf
    v_add_f32_dpp v33, v33, v33 row_half_mirror row_mask:0xf bank_mask:0xf
    v_add_f32_dpp v34, v34, v34 row_half_mirror row_mask:0xf bank_mask:0xf
    v_add_f32_dpp v35, v35, v35 row_half_mirror row_mask:0xf bank_mask:0xf
    v_add_f32_dpp v32, v32, v32 quad_perm:[1,0,3,2] row_mask:0xf bank_mask:0xf
    v_add_f32_dpp v33, v33, v33 quad_perm:[1,0,3,2] row_mask:0xf bank_mask:0xf
    v_add_f32_dpp v34, v34, v34 quad_perm:[1,0,3,2] row_mask:0xf bank_mask:0xf
    v_add_f32_dpp v35, v35, v35 quad_perm:[1,0,3,2] row_mask:0xf bank_mask:0xf
    v_add_f32_dpp v32, v32, v32 quad_perm:[2,3,0,1] row_mask:0xf bank_mask:0xf
    v_add_f32_dpp v33, v33, v33 quad_perm:[2,3,0,1] row_mask:0xf bank_mask:0xf
    v_add_f32_dpp v34, v34, v34 quad_perm:[2,3,0,1] row_mask:0xf bank_mask:0xf
    v_add_f32_dpp v35, v35, v35 quad_perm:[2,3,0,1] row_mask:0xf bank_mask:0xf
    v_max3_f32 v26, v32, v33, v24
    v_max3_f32 v26, v34, v35, v26
    v_mov_b32 v27, v26
    s_nop 1
    v_permlane16_swap_b32 v26, v27
    v_max_f32 v26, v26, v27
    v_mov_b32 v27, v26
    s_nop 1
    v_permlane32_swap_b32 v26, v27
    v_max_f32 v26, v26, v27
    v_sub_f32 v27, v24, v26
    v_mul_f32 v27, s30, v27
    v_exp_f32 v29, v27
    v_mul_f32 v30, s30, v26
    v_mov_b32 v24, v26
    v_fma_f32 v32, v32, s30, -v30
    v_fma_f32 v33, v33, s30, -v30
    v_fma_f32 v34, v34, s30, -v30
    v_fma_f32 v35, v35, s30, -v30
    v_exp_f32 v32, v32
    v_exp_f32 v33, v33
    v_exp_f32 v34, v34
    v_exp_f32 v35, v35
    v_mul_f32 v20, v20, v29
    v_mul_f32 v21, v21, v29
    v_mul_f32 v22, v22, v29
    v_mul_f32 v23, v23, v29
    v_mul_f32 v25, v25, v29
    v_add_f32 v25, v25, v32
    v_cvt_pk_bf16_f32 v40, v32, v32
    v_add_f32 v25, v25, v33
    v_cvt_pk_bf16_f32 v41, v33, v33
    v_add_f32 v25, v25, v34
    v_cvt_pk_bf16_f32 v42, v34, v34
    v_add_f32 v25, v25, v35
    v_cvt_pk_bf16_f32 v43, v35, v35
    v_and_b32 v4, v40, v16
    v_and_b32 v5, v40, v17
    v_and_b32 v6, v40, v18
    v_and_b32 v7, v40, v19
    s_nop 1
    v_mfma_f32_16x16x32_bf16 v[20:23], v[80:83], v[4:7], v[20:23]
    v_and_b32 v48, v41, v16
    v_and_b32 v49, v41, v17
    v_and_b32 v50, v41, v18
    v_and_b32 v51, v41, v19
    s_nop 1
    v_mfma_f32_16x16x32_bf16 v[20:23], v[84:87], v[48:51], v[20:23]
    v_and_b32 v4, v42, v16
    v_and_b32 v5, v42, v17
    v_and_b32 v6, v42, v18
    v_and_b32 v7, v42, v19
    s_nop 1
    v_mfma_f32_16x16x32_bf16 v[20:23], v[88:91], v[4:7], v[20:23]
    v_and_b32 v48, v43, v16
    v_and_b32 v49, v43, v17
    v_and_b32 v50, v43, v18
    v_and_b32 v51, v43, v19
    s_nop 1
    v_mfma_f32_16x16x32_bf16 v[20:23], v[92:95], v[48:51], v[20:23]
    v_add_u32 v52, 32, v52
    s_add_u32 s29, s26, s45
    s_and_b32 s29, s29, 2047
    s_bfe_u32 s31, s29, 0x20004
    s_lshl_b32 s31, s31, 9
    s_lshr_b32 s28, s29, 6
    s_lshl_b32 s28, s28, 4
    s_or_b32 s31, s31, s28
    s_and_b32 s29, s29, 15
    s_or_b32 s29, s29, s31
    s_lshl_b32 s29, s29, 12
    s_add_u32 s29, s29, s24
    s_cmp_lt_u32 s26, 2048
    s_cselect_b32 s80, s29, 0x10000000
    buffer_load_dword v60, v61, s[40:43], 0 offen
    buffer_load_dwordx4 v[64:67], v2, s[32:35], s80 offen offset:0 nt
    buffer_load_dwordx4 v[68:71], v2, s[32:35], s80 offen offset:1024 nt
    buffer_load_dwordx4 v[72:75], v2, s[32:35], s80 offen offset:2048 nt
    buffer_load_dwordx4 v[76:79], v2, s[32:35], s80 offen offset:3072 nt
    buffer_load_dwordx4 v[80:83], v2, s[36:39], s80 offen offset:0 nt
    buffer_load_dwordx4 v[84:87], v2, s[36:39], s80 offen offset:1024 nt
    buffer_load_dwordx4 v[88:91], v2, s[36:39], s80 offen offset:2048 nt
    buffer_load_dwordx4 v[92:95], v2, s[36:39], s80 offen offset:3072 nt
    v_dot2_f32_bf16 v32, v96, v8, 0
    v_dot2_f32_bf16 v40, v96, v12, 0
    v_dot2_f32_bf16 v32, v97, v9, v32
    v_dot2_f32_bf16 v40, v97, v13, v40
    v_dot2_f32_bf16 v32, v98, v10, v32
    v_dot2_f32_bf16 v40, v98, v14, v40
    v_dot2_f32_bf16 v32, v99, v11, v32
    v_dot2_f32_bf16 v40, v99, v15, v40
    v_dot2_f32_bf16 v33, v100, v8, 0
    v_dot2_f32_bf16 v41, v100, v12, 0
    v_dot2_f32_bf16 v33, v101, v9, v33
    v_dot2_f32_bf16 v41, v101, v13, v41
    v_dot2_f32_bf16 v33, v102, v10, v33
    v_dot2_f32_bf16 v41, v102, v14, v41
    v_dot2_f32_bf16 v33, v103, v11, v33
    v_dot2_f32_bf16 v41, v103, v15, v41
    v_dot2_f32_bf16 v34, v104, v8, 0
    v_dot2_f32_bf16 v42, v104, v12, 0
    v_dot2_f32_bf16 v34, v105, v9, v34
    v_dot2_f32_bf16 v42, v105, v13, v42
    v_dot2_f32_bf16 v34, v106, v10, v34
    v_dot2_f32_bf16 v42, v106, v14, v42
    v_dot2_f32_bf16 v34, v107, v11, v34
    v_dot2_f32_bf16 v42, v107, v15, v42
    v_dot2_f32_bf16 v35, v108, v8, 0
    v_dot2_f32_bf16 v43, v108, v12, 0
    v_dot2_f32_bf16 v35, v109, v9, v35
    v_dot2_f32_bf16 v43, v109, v13, v43
    v_dot2_f32_bf16 v35, v110, v10, v35
    v_dot2_f32_bf16 v43, v110, v14, v43
    v_dot2_f32_bf16 v35, v111, v11, v35
    v_dot2_f32_bf16 v43, v111, v15, v43
    v_add_f32_dpp v32, v40, v32 row_ror:8 row_mask:0xf bank_mask:0xf
    v_add_f32_dpp v33, v41, v33 row_ror:8 row_mask:0xf bank_mask:0xf
    v_add_f32_dpp v34, v42, v34 row_ror:8 row_mask:0xf bank_mask:0xf
    v_add_f32_dpp v35, v43, v35 row_ror:8 row_mask:0xf bank_mask:0xf
    v_add_f32_dpp v32, v32, v32 row_half_mirror row_mask:0xf bank_mask:0xf
    v_add_f32_dpp v33, v33, v33 row_half_mirror row_mask:0xf bank_mask:0xf
    v_add_f32_dpp v34, v34, v34 row_half_mirror row_mask:0xf bank_mask:0xf
    v_add_f32_dpp v35, v35, v35 row_half_mirror row_mask:0xf bank_mask:0xf
    v_add_f32_dpp v32, v32, v32 quad_perm:[1,0,3,2] row_mask:0xf bank_mask:0xf
    v_add_f32_dpp v33, v33, v33 quad_perm:[1,0,3,2] row_mask:0xf bank_mask:0xf
    v_add_f32_dpp v34, v34, v34 quad_perm:[1,0,3,2] row_mask:0xf bank_mask:0xf
    v_add_f32_dpp v35, v35, v35 quad_perm:[1,0,3,2] row_mask:0xf bank_mask:0xf
    v_add_f32_dpp v32, v32, v32 quad_perm:[2,3,0,1] row_mask:0xf bank_mask:0xf
    v_add_f32_dpp v33, v33, v33 quad_perm:[2,3,0,1] row_mask:0xf bank_mask:0xf
    v_add_f32_dpp v34, v34, v34 quad_perm:[2,3,0,1] row_mask:0xf bank_mask:0xf
    v_add_f32_dpp v35, v35, v35 quad_perm:[2,3,0,1] row_mask:0xf bank_mask:0xf
    v_max3_f32 v26, v32, v33, v24
    v_max3_f32 v26, v34, v35, v26
    v_mov_b32 v27, v26
    s_nop 1
    v_permlane16_swap_b32 v26, v27
    v_max_f32 v26, v26, v27
    v_mov_b32 v27, v26
    s_nop 1
    v_permlane32_swap_b32 v26, v27
    v_max_f32 v26, v26, v27
    v_sub_f32 v27, v24, v26
    v_mul_f32 v27, s30, v27
    v_exp_f32 v29, v27
    v_mul_f32 v30, s30, v26
    v_mov_b32 v24, v26
    v_fma_f32 v32, v32, s30, -v30
    v_fma_f32 v33, v33, s30, -v30
    v_fma_f32 v34, v34, s30, -v30
    v_fma_f32 v35, v35, s30, -v30
    v_exp_f32 v32, v32
    v_exp_f32 v33, v33
    v_exp_f32 v34, v34
    v_exp_f32 v35, v35
    v_mul_f32 v20, v20, v29
    v_mul_f32 v21, v21, v29
    v_mul_f32 v22, v22, v29
    v_mul_f32 v23, v23, v29
    v_mul_f32 v25, v25, v29
    v_add_f32 v25, v25, v32
    v_cvt_pk_bf16_f32 v40, v32, v32
    v_add_f32 v25, v25, v33
    v_cvt_pk_bf16_f32 v41, v33, v33
    v_add_f32 v25, v25, v34
    v_cvt_pk_bf16_f32 v42, v34, v34
    v_add_f32 v25, v25, v35
    v_cvt_pk_bf16_f32 v43, v35, v35
    v_and_b32 v4, v40, v16
    v_and_b32 v5, v40, v17
    v_and_b32 v6, v40, v18
    v_and_b32 v7, v40, v19
    s_nop 1
    v_mfma_f32_16x16x32_bf16 v[20:23], v[112:115], v[4:7], v[20:23]
    v_and_b32 v48, v41, v16
    v_and_b32 v49, v41, v17
    v_and_b32 v50, v41, v18
    v_and_b32 v51, v41, v19
    s_nop 1
    v_mfma_f32_16x16x32_bf16 v[20:23], v[116:119], v[48:51], v[20:23]
    v_and_b32 v4, v42, v16
    v_and_b32 v5, v42, v17
    v_and_b32 v6, v42, v18
    v_and_b32 v7, v42, v19
    s_nop 1
    v_mfma_f32_16x16x32_bf16 v[20:23], v[120:123], v[4:7], v[20:23]
    v_and_b32 v48, v43, v16
    v_and_b32 v49, v43, v17
    v_and_b32 v50, v43, v18
    v_and_b32 v51, v43, v19
    s_nop 1
    v_mfma_f32_16x16x32_bf16 v[20:23], v[124:127], v[48:51], v[20:23]
    v_dot2_f32_bf16 v32, v128, v8, 0
    v_dot2_f32_bf16 v40, v128, v12, 0
    v_dot2_f32_bf16 v32, v129, v9, v32
    v_dot2_f32_bf16 v40, v129, v13, v40
    v_dot2_f32_bf16 v32, v130, v10, v32
    v_dot2_f32_bf16 v40, v130, v14, v40
    v_dot2_f32_bf16 v32, v131, v11, v32
    v_dot2_f32_bf16 v40, v131, v15, v40
    v_dot2_f32_bf16 v33, v132, v8, 0
    v_dot2_f32_bf16 v41, v132, v12, 0
    v_dot2_f32_bf16 v33, v133, v9, v33
    v_dot2_f32_bf16 v41, v133, v13, v41
    v_dot2_f32_bf16 v33, v134, v10, v33
    v_dot2_f32_bf16 v41, v134, v14, v41
    v_dot2_f32_bf16 v33, v135, v11, v33
    v_dot2_f32_bf16 v41, v135, v15, v41
    v_dot2_f32_bf16 v34, v136, v8, 0
    v_dot2_f32_bf16 v42, v136, v12, 0
    v_dot2_f32_bf16 v34, v137, v9, v34
    v_dot2_f32_bf16 v42, v137, v13, v42
    v_dot2_f32_bf16 v34, v138, v10, v34
    v_dot2_f32_bf16 v42, v138, v14, v42
    v_dot2_f32_bf16 v34, v139, v11, v34
    v_dot2_f32_bf16 v42, v139, v15, v42
    v_dot2_f32_bf16 v35, v140, v8, 0
    v_dot2_f32_bf16 v43, v140, v12, 0
    v_dot2_f32_bf16 v35, v141, v9, v35
    v_dot2_f32_bf16 v43, v141, v13, v43
    v_dot2_f32_bf16 v35, v142, v10, v35
    v_dot2_f32_bf16 v43, v142, v14, v43
    v_dot2_f32_bf16 v35, v143, v11, v35
    v_dot2_f32_bf16 v43, v143, v15, v43
    v_add_f32_dpp v32, v40, v32 row_ror:8 row_mask:0xf bank_mask:0xf
    v_add_f32_dpp v33, v41, v33 row_ror:8 row_mask:0xf bank_mask:0xf
    v_add_f32_dpp v34, v42, v34 row_ror:8 row_mask:0xf bank_mask:0xf
    v_add_f32_dpp v35, v43, v35 row_ror:8 row_mask:0xf bank_mask:0xf
    v_add_f32_dpp v32, v32, v32 row_half_mirror row_mask:0xf bank_mask:0xf
    v_add_f32_dpp v33, v33, v33 row_half_mirror row_mask:0xf bank_mask:0xf
    v_add_f32_dpp v34, v34, v34 row_half_mirror row_mask:0xf bank_mask:0xf
    v_add_f32_dpp v35, v35, v35 row_half_mirror row_mask:0xf bank_mask:0xf
    v_add_f32_dpp v32, v32, v32 quad_perm:[1,0,3,2] row_mask:0xf bank_mask:0xf
    v_add_f32_dpp v33, v33, v33 quad_perm:[1,0,3,2] row_mask:0xf bank_mask:0xf
    v_add_f32_dpp v34, v34, v34 quad_perm:[1,0,3,2] row_mask:0xf bank_mask:0xf
    v_add_f32_dpp v35, v35, v35 quad_perm:[1,0,3,2] row_mask:0xf bank_mask:0xf
    v_add_f32_dpp v32, v32, v32 quad_perm:[2,3,0,1] row_mask:0xf bank_mask:0xf
    v_add_f32_dpp v33, v33, v33 quad_perm:[2,3,0,1] row_mask:0xf bank_mask:0xf
    v_add_f32_dpp v34, v34, v34 quad_perm:[2,3,0,1] row_mask:0xf bank_mask:0xf
    v_add_f32_dpp v35, v35, v35 quad_perm:[2,3,0,1] row_mask:0xf bank_mask:0xf
    v_max3_f32 v26, v32, v33, v24
    v_max3_f32 v26, v34, v35, v26
    v_mov_b32 v27, v26
    s_nop 1
    v_permlane16_swap_b32 v26, v27
    v_max_f32 v26, v26, v27
    v_mov_b32 v27, v26
    s_nop 1
    v_permlane32_swap_b32 v26, v27
    v_max_f32 v26, v26, v27
    v_sub_f32 v27, v24, v26
    v_mul_f32 v27, s30, v27
    v_exp_f32 v29, v27
    v_mul_f32 v30, s30, v26
    v_mov_b32 v24, v26
    v_fma_f32 v32, v32, s30, -v30
    v_fma_f32 v33, v33, s30, -v30
    v_fma_f32 v34, v34, s30, -v30
    v_fma_f32 v35, v35, s30, -v30
    v_exp_f32 v32, v32
    v_exp_f32 v33, v33
    v_exp_f32 v34, v34
    v_exp_f32 v35, v35
    v_mul_f32 v20, v20, v29
    v_mul_f32 v21, v21, v29
    v_mul_f32 v22, v22, v29
    v_mul_f32 v23, v23, v29
    v_mul_f32 v25, v25, v29
    v_add_f32 v25, v25, v32
    v_cvt_pk_bf16_f32 v40, v32, v32
    v_add_f32 v25, v25, v33
    v_cvt_pk_bf16_f32 v41, v33, v33
    v_add_f32 v25, v25, v34
    v_cvt_pk_bf16_f32 v42, v34, v34
    v_add_f32 v25, v25, v35
    v_cvt_pk_bf16_f32 v43, v35, v35
    v_and_b32 v4, v40, v16
    v_and_b32 v5, v40, v17
    v_and_b32 v6, v40, v18
    v_and_b32 v7, v40, v19
    s_nop 1
    v_mfma_f32_16x16x32_bf16 v[20:23], v[144:147], v[4:7], v[20:23]
    v_and_b32 v48, v41, v16
    v_and_b32 v49, v41, v17
    v_and_b32 v50, v41, v18
    v_and_b32 v51, v41, v19
    s_nop 1
    v_mfma_f32_16x16x32_bf16 v[20:23], v[148:151], v[48:51], v[20:23]
    v_and_b32 v4, v42, v16
    v_and_b32 v5, v42, v17
    v_and_b32 v6, v42, v18
    v_and_b32 v7, v42, v19
    s_nop 1
    v_mfma_f32_16x16x32_bf16 v[20:23], v[152:155], v[4:7], v[20:23]
    v_and_b32 v48, v43, v16
    v_and_b32 v49, v43, v17
    v_and_b32 v50, v43, v18
    v_and_b32 v51, v43, v19
    s_nop 1
    v_mfma_f32_16x16x32_bf16 v[20:23], v[156:159], v[48:51], v[20:23]
    v_dot2_f32_bf16 v32, v160, v8, 0
    v_dot2_f32_bf16 v40, v160, v12, 0
    v_dot2_f32_bf16 v32, v161, v9, v32
    v_dot2_f32_bf16 v40, v161, v13, v40
    v_dot2_f32_bf16 v32, v162, v10, v32
    v_dot2_f32_bf16 v40, v162, v14, v40
    v_dot2_f32_bf16 v32, v163, v11, v32
    v_dot2_f32_bf16 v40, v163, v15, v40
    v_dot2_f32_bf16 v33, v164, v8, 0
    v_dot2_f32_bf16 v41, v164, v12, 0
    v_dot2_f32_bf16 v33, v165, v9, v33
    v_dot2_f32_bf16 v41, v165, v13, v41
    v_dot2_f32_bf16 v33, v166, v10, v33
    v_dot2_f32_bf16 v41, v166, v14, v41
    v_dot2_f32_bf16 v33, v167, v11, v33
    v_dot2_f32_bf16 v41, v167, v15, v41
    v_dot2_f32_bf16 v34, v168, v8, 0
    v_dot2_f32_bf16 v42, v168, v12, 0
    v_dot2_f32_bf16 v34, v169, v9, v34
    v_dot2_f32_bf16 v42, v169, v13, v42
    v_dot2_f32_bf16 v34, v170, v10, v34
    v_dot2_f32_bf16 v42, v170, v14, v42
    v_dot2_f32_bf16 v34, v171, v11, v34
    v_dot2_f32_bf16 v42, v171, v15, v42
    v_dot2_f32_bf16 v35, v172, v8, 0
    v_dot2_f32_bf16 v43, v172, v12, 0
    v_dot2_f32_bf16 v35, v173, v9, v35
    v_dot2_f32_bf16 v43, v173, v13, v43
    v_dot2_f32_bf16 v35, v174, v10, v35
    v_dot2_f32_bf16 v43, v174, v14, v43
    v_dot2_f32_bf16 v35, v175, v11, v35
    v_dot2_f32_bf16 v43, v175, v15, v43
    v_add_f32_dpp v32, v40, v32 row_ror:8 row_mask:0xf bank_mask:0xf
    v_add_f32_dpp v33, v41, v33 row_ror:8 row_mask:0xf bank_mask:0xf
    v_add_f32_dpp v34, v42, v34 row_ror:8 row_mask:0xf bank_mask:0xf
    v_add_f32_dpp v35, v43, v35 row_ror:8 row_mask:0xf bank_mask:0xf
    v_add_f32_dpp v32, v32, v32 row_half_mirror row_mask:0xf bank_mask:0xf
    v_add_f32_dpp v33, v33, v33 row_half_mirror row_mask:0xf bank_mask:0xf
    v_add_f32_dpp v34, v34, v34 row_half_mirror row_mask:0xf bank_mask:0xf
    v_add_f32_dpp v35, v35, v35 row_half_mirror row_mask:0xf bank_mask:0xf
    v_add_f32_dpp v32, v32, v32 quad_perm:[1,0,3,2] row_mask:0xf bank_mask:0xf
    v_add_f32_dpp v33, v33, v33 quad_perm:[1,0,3,2] row_mask:0xf bank_mask:0xf
    v_add_f32_dpp v34, v34, v34 quad_perm:[1,0,3,2] row_mask:0xf bank_mask:0xf
    v_add_f32_dpp v35, v35, v35 quad_perm:[1,0,3,2] row_mask:0xf bank_mask:0xf
    v_add_f32_dpp v32, v32, v32 quad_perm:[2,3,0,1] row_mask:0xf bank_mask:0xf
    v_add_f32_dpp v33, v33, v33 quad_perm:[2,3,0,1] row_mask:0xf bank_mask:0xf
    v_add_f32_dpp v34, v34, v34 quad_perm:[2,3,0,1] row_mask:0xf bank_mask:0xf
    v_add_f32_dpp v35, v35, v35 quad_perm:[2,3,0,1] row_mask:0xf bank_mask:0xf
    v_max3_f32 v26, v32, v33, v24
    v_max3_f32 v26, v34, v35, v26
    v_mov_b32 v27, v26
    s_nop 1
    v_permlane16_swap_b32 v26, v27
    v_max_f32 v26, v26, v27
    v_mov_b32 v27, v26
    s_nop 1
    v_permlane32_swap_b32 v26, v27
    v_max_f32 v26, v26, v27
    v_sub_f32 v27, v24, v26
    v_mul_f32 v27, s30, v27
    v_exp_f32 v29, v27
    v_mul_f32 v30, s30, v26
    v_mov_b32 v24, v26
    v_fma_f32 v32, v32, s30, -v30
    v_fma_f32 v33, v33, s30, -v30
    v_fma_f32 v34, v34, s30, -v30
    v_fma_f32 v35, v35, s30, -v30
    v_exp_f32 v32, v32
    v_exp_f32 v33, v33
    v_exp_f32 v34, v34
    v_exp_f32 v35, v35
    v_mul_f32 v20, v20, v29
    v_mul_f32 v21, v21, v29
    v_mul_f32 v22, v22, v29
    v_mul_f32 v23, v23, v29
    v_mul_f32 v25, v25, v29
    v_add_f32 v25, v25, v32
    v_cvt_pk_bf16_f32 v40, v32, v32
    v_add_f32 v25, v25, v33
    v_cvt_pk_bf16_f32 v41, v33, v33
    v_add_f32 v25, v25, v34
    v_cvt_pk_bf16_f32 v42, v34, v34
    v_add_f32 v25, v25, v35
    v_cvt_pk_bf16_f32 v43, v35, v35
    v_and_b32 v4, v40, v16
    v_and_b32 v5, v40, v17
    v_and_b32 v6, v40, v18
    v_and_b32 v7, v40, v19
    s_nop 1
    v_mfma_f32_16x16x32_bf16 v[20:23], v[176:179], v[4:7], v[20:23]
    v_and_b32 v48, v41, v16
    v_and_b32 v49, v41, v17
    v_and_b32 v50, v41, v18
    v_and_b32 v51, v41, v19
    s_nop 1
    v_mfma_f32_16x16x32_bf16 v[20:23], v[180:183], v[48:51], v[20:23]
    v_and_b32 v4, v42, v16
    v_and_b32 v5, v42, v17
    v_and_b32 v6, v42, v18
    v_and_b32 v7, v42, v19
    s_nop 1
    v_mfma_f32_16x16x32_bf16 v[20:23], v[184:187], v[4:7], v[20:23]
    v_and_b32 v48, v43, v16
    v_and_b32 v49, v43, v17
    v_and_b32 v50, v43, v18
    v_and_b32 v51, v43, v19
    s_nop 1
    v_mfma_f32_16x16x32_bf16 v[20:23], v[188:191], v[48:51], v[20:23]
    s_waitcnt vmcnt(13)
    v_dot2_f32_bf16 v32, v192, v8, 0
    v_dot2_f32_bf16 v40, v192, v12, 0
    v_dot2_f32_bf16 v32, v193, v9, v32
    v_dot2_f32_bf16 v40, v193, v13, v40
    v_dot2_f32_bf16 v32, v194, v10, v32
    v_dot2_f32_bf16 v40, v194, v14, v40
    v_dot2_f32_bf16 v32, v195, v11, v32
    v_dot2_f32_bf16 v40, v195, v15, v40
    v_dot2_f32_bf16 v33, v196, v8, 0
    v_dot2_f32_bf16 v41, v196, v12, 0
    v_dot2_f32_bf16 v33, v197, v9, v33
    v_dot2_f32_bf16 v41, v197, v13, v41
    v_dot2_f32_bf16 v33, v198, v10, v33
    v_dot2_f32_bf16 v41, v198, v14, v41
    v_dot2_f32_bf16 v33, v199, v11, v33
    v_dot2_f32_bf16 v41, v199, v15, v41
    v_dot2_f32_bf16 v34, v200, v8, 0
    v_dot2_f32_bf16 v42, v200, v12, 0
    v_dot2_f32_bf16 v34, v201, v9, v34
    v_dot2_f32_bf16 v42, v201, v13, v42
    v_dot2_f32_bf16 v34, v202, v10, v34
    v_dot2_f32_bf16 v42, v202, v14, v42
    v_dot2_f32_bf16 v34, v203, v11, v34
    v_dot2_f32_bf16 v42, v203, v15, v42
    v_dot2_f32_bf16 v35, v204, v8, 0
    v_dot2_f32_bf16 v43, v204, v12, 0
    v_dot2_f32_bf16 v35, v205, v9, v35
    v_dot2_f32_bf16 v43, v205, v13, v43
    v_dot2_f32_bf16 v35, v206, v10, v35
    v_dot2_f32_bf16 v43, v206, v14, v43
    v_dot2_f32_bf16 v35, v207, v11, v35
    v_dot2_f32_bf16 v43, v207, v15, v43
    v_add_f32_dpp v32, v40, v32 row_ror:8 row_mask:0xf bank_mask:0xf
    v_add_f32_dpp v33, v41, v33 row_ror:8 row_mask:0xf bank_mask:0xf
    v_add_f32_dpp v34, v42, v34 row_ror:8 row_mask:0xf bank_mask:0xf
    v_add_f32_dpp v35, v43, v35 row_ror:8 row_mask:0xf bank_mask:0xf
    v_add_f32_dpp v32, v32, v32 row_half_mirror row_mask:0xf bank_mask:0xf
    v_add_f32_dpp v33, v33, v33 row_half_mirror row_mask:0xf bank_mask:0xf
    v_add_f32_dpp v34, v34, v34 row_half_mirror row_mask:0xf bank_mask:0xf
    v_add_f32_dpp v35, v35, v35 row_half_mirror row_mask:0xf bank_mask:0xf
    v_add_f32_dpp v32, v32, v32 quad_perm:[1,0,3,2] row_mask:0xf bank_mask:0xf
    v_add_f32_dpp v33, v33, v33 quad_perm:[1,0,3,2] row_mask:0xf bank_mask:0xf
    v_add_f32_dpp v34, v34, v34 quad_perm:[1,0,3,2] row_mask:0xf bank_mask:0xf
    v_add_f32_dpp v35, v35, v35 quad_perm:[1,0,3,2] row_mask:0xf bank_mask:0xf
    v_add_f32_dpp v32, v32, v32 quad_perm:[2,3,0,1] row_mask:0xf bank_mask:0xf
    v_add_f32_dpp v33, v33, v33 quad_perm:[2,3,0,1] row_mask:0xf bank_mask:0xf
    v_add_f32_dpp v34, v34, v34 quad_perm:[2,3,0,1] row_mask:0xf bank_mask:0xf
    v_add_f32_dpp v35, v35, v35 quad_perm:[2,3,0,1] row_mask:0xf bank_mask:0xf
    v_max3_f32 v26, v32, v33, v24
    v_max3_f32 v26, v34, v35, v26
    v_mov_b32 v27, v26
    s_nop 1
    v_permlane16_swap_b32 v26, v27
    v_max_f32 v26, v26, v27
    v_mov_b32 v27, v26
    s_nop 1
    v_permlane32_swap_b32 v26, v27
    v_max_f32 v26, v26, v27
    v_sub_f32 v27, v24, v26
    v_mul_f32 v27, s30, v27
    v_exp_f32 v29, v27
    v_mul_f32 v30, s30, v26
    v_mov_b32 v24, v26
    v_fma_f32 v32, v32, s30, -v30
    v_fma_f32 v33, v33, s30, -v30
    v_fma_f32 v34, v34, s30, -v30
    v_fma_f32 v35, v35, s30, -v30
    v_exp_f32 v32, v32
    v_exp_f32 v33, v33
    v_exp_f32 v34, v34
    v_exp_f32 v35, v35
    v_mul_f32 v20, v20, v29
    v_mul_f32 v21, v21, v29
    v_mul_f32 v22, v22, v29
    v_mul_f32 v23, v23, v29
    v_mul_f32 v25, v25, v29
    v_add_f32 v25, v25, v32
    v_cvt_pk_bf16_f32 v40, v32, v32
    v_add_f32 v25, v25, v33
    v_cvt_pk_bf16_f32 v41, v33, v33
    v_add_f32 v25, v25, v34
    v_cvt_pk_bf16_f32 v42, v34, v34
    v_add_f32 v25, v25, v35
    v_cvt_pk_bf16_f32 v43, v35, v35
    s_waitcnt vmcnt(9)
    v_and_b32 v4, v40, v16
    v_and_b32 v5, v40, v17
    v_and_b32 v6, v40, v18
    v_and_b32 v7, v40, v19
    s_nop 1
    v_mfma_f32_16x16x32_bf16 v[20:23], v[208:211], v[4:7], v[20:23]
    v_and_b32 v48, v41, v16
    v_and_b32 v49, v41, v17
    v_and_b32 v50, v41, v18
    v_and_b32 v51, v41, v19
    s_nop 1
    v_mfma_f32_16x16x32_bf16 v[20:23], v[212:215], v[48:51], v[20:23]
    v_and_b32 v4, v42, v16
    v_and_b32 v5, v42, v17
    v_and_b32 v6, v42, v18
    v_and_b32 v7, v42, v19
    s_nop 1
    v_mfma_f32_16x16x32_bf16 v[20:23], v[216:219], v[4:7], v[20:23]
    v_and_b32 v48, v43, v16
    v_and_b32 v49, v43, v17
    v_and_b32 v50, v43, v18
    v_and_b32 v51, v43, v19
    s_nop 1
    v_mfma_f32_16x16x32_bf16 v[20:23], v[220:223], v[48:51], v[20:23]
    v_lshrrev_b32 v62, 4, v1
    v_bfe_u32 v63, v1, 3, 1
    v_lshl_add_u32 v27, v62, 1, v63
    v_mul_u32_u24 v27, 1152, v27
    v_and_b32 v28, 7, v1
    v_lshl_add_u32 v27, v28, 4, v27
    s_sub_u32 s27, s20, 1
    s_and_b32 s25, s2, 15
    s_mul_i32 s28, s21, 4
    s_add_u32 s28, s28, s27
    s_mul_i32 s28, s28, 73728
    s_lshl_b32 s29, s25, 7
    s_add_u32 s28, s28, s29
    s_cmp_lt_u32 s25, 9
    s_cselect_b32 s28, s28, 0x10000000
    buffer_load_dwordx4 v[96:99], v27, s[56:59], s28 offen nt
    s_add_u32 s28, s28, 9216
    buffer_load_dwordx4 v[100:103], v27, s[56:59], s28 offen nt
    s_add_u32 s28, s28, 9216
    buffer_load_dwordx4 v[104:107], v27, s[56:59], s28 offen nt
    s_add_u32 s28, s28, 9216
    buffer_load_dwordx4 v[108:111], v27, s[56:59], s28 offen nt
    s_add_u32 s28, s28, 9216
    buffer_load_dwordx4 v[112:115], v27, s[56:59], s28 offen nt
    s_add_u32 s28, s28, 9216
    buffer_load_dwordx4 v[116:119], v27, s[56:59], s28 offen nt
    s_add_u32 s28, s28, 9216
    buffer_load_dwordx4 v[120:123], v27, s[56:59], s28 offen nt
    s_add_u32 s28, s28, 9216
    buffer_load_dwordx4 v[124:127], v27, s[56:59], s28 offen nt
    s_add_u32 s28, s28, 9216
    s_mov_b32 s46, 51
L_sloop:
    s_waitcnt vmcnt(4)
    v_readfirstlane_b32 s26, v52
    v_dot2_f32_bf16 v32, v64, v8, 0
    v_dot2_f32_bf16 v40, v64, v12, 0
    v_dot2_f32_bf16 v32, v65, v9, v32
    v_dot2_f32_bf16 v40, v65, v13, v40
    v_dot2_f32_bf16 v32, v66, v10, v32
    v_dot2_f32_bf16 v40, v66, v14, v40
    v_dot2_f32_bf16 v32, v67, v11, v32
    v_dot2_f32_bf16 v40, v67, v15, v40
    v_dot2_f32_bf16 v33, v68, v8, 0
    v_dot2_f32_bf16 v41, v68, v12, 0
    v_dot2_f32_bf16 v33, v69, v9, v33
    v_dot2_f32_bf16 v41, v69, v13, v41
    v_dot2_f32_bf16 v33, v70, v10, v33
    v_dot2_f32_bf16 v41, v70, v14, v41
    v_dot2_f32_bf16 v33, v71, v11, v33
    v_dot2_f32_bf16 v41, v71, v15, v41
    v_dot2_f32_bf16 v34, v72, v8, 0
    v_dot2_f32_bf16 v42, v72, v12, 0
    v_dot2_f32_bf16 v34, v73, v9, v34
    v_dot2_f32_bf16 v42, v73, v13, v42
    v_dot2_f32_bf16 v34, v74, v10, v34
    v_dot2_f32_bf16 v42, v74, v14, v42
    v_dot2_f32_bf16 v34, v75, v11, v34
    v_dot2_f32_bf16 v42, v75, v15, v42
    v_dot2_f32_bf16 v35, v76, v8, 0
    v_dot2_f32_bf16 v43, v76, v12, 0
    v_dot2_f32_bf16 v35, v77, v9, v35
    v_dot2_f32_bf16 v43, v77, v13, v43
    v_dot2_f32_bf16 v35, v78, v10, v35
    v_dot2_f32_bf16 v43, v78, v14, v43
    v_dot2_f32_bf16 v35, v79, v11, v35
    v_dot2_f32_bf16 v43, v79, v15, v43
    v_add_f32_dpp v32, v40, v32 row_ror:8 row_mask:0xf bank_mask:0xf
    v_add_f32_dpp v33, v41, v33 row_ror:8 row_mask:0xf bank_mask:0xf
    v_add_f32_dpp v34, v42, v34 row_ror:8 row_mask:0xf bank_mask:0xf
    v_add_f32_dpp v35, v43, v35 row_ror:8 row_mask:0xf bank_mask:0xf
    v_add_f32_dpp v32, v32, v32 row_half_mirror row_mask:0xf bank_mask:0xf
    v_add_f32_dpp v33, v33, v33 row_half_mirror row_mask:0xf bank_mask:0xf
    v_add_f32_dpp v34, v34, v34 row_half_mirror row_mask:0xf bank_mask:0xf
    v_add_f32_dpp v35, v35, v35 row_half_mirror row_mask:0xf bank_mask:0xf
    v_add_f32_dpp v32, v32, v32 quad_perm:[1,0,3,2] row_mask:0xf bank_mask:0xf
    v_add_f32_dpp v33, v33, v33 quad_perm:[1,0,3,2] row_mask:0xf bank_mask:0xf
    v_add_f32_dpp v34, v34, v34 quad_perm:[1,0,3,2] row_mask:0xf bank_mask:0xf
    v_add_f32_dpp v35, v35, v35 quad_perm:[1,0,3,2] row_mask:0xf bank_mask:0xf
    v_add_f32_dpp v32, v32, v32 quad_perm:[2,3,0,1] row_mask:0xf bank_mask:0xf
    v_add_f32_dpp v33, v33, v33 quad_perm:[2,3,0,1] row_mask:0xf bank_mask:0xf
    v_add_f32_dpp v34, v34, v34 quad_perm:[2,3,0,1] row_mask:0xf bank_mask:0xf
    v_add_f32_dpp v35, v35, v35 quad_perm:[2,3,0,1] row_mask:0xf bank_mask:0xf
    v_max3_f32 v26, v32, v33, v24
    v_max3_f32 v26, v34, v35, v26
    v_mov_b32 v27, v26
    s_nop 1
    v_permlane16_swap_b32 v26, v27
    v_max_f32 v26, v26, v27
    v_mov_b32 v27, v26
    s_nop 1
    v_permlane32_swap_b32 v26, v27
    v_max_f32 v26, v26, v27
    v_sub_f32 v27, v24, v26
    v_mul_f32 v27, s30, v27
    v_exp_f32 v29, v27
    v_mul_f32 v30, s30, v26
    v_mov_b32 v24, v26
    v_fma_f32 v32, v32, s30, -v30
    v_fma_f32 v33, v33, s30, -v30
    v_fma_f32 v34, v34, s30, -v30
    v_fma_f32 v35, v35, s30, -v30
    v_exp_f32 v32, v32
    v_exp_f32 v33, v33
    v_exp_f32 v34, v34
    v_exp_f32 v35, v35
    v_mul_f32 v20, v20, v29
    v_mul_f32 v21, v21, v29
    v_mul_f32 v22, v22, v29
    v_mul_f32 v23, v23, v29
    v_mul_f32 v25, v25, v29
    v_add_f32 v25, v25, v32
    v_cvt_pk_bf16_f32 v40, v32, v32
    v_add_f32 v25, v25, v33
    v_cvt_pk_bf16_f32 v41, v33, v33
    v_add_f32 v25, v25, v34
    v_cvt_pk_bf16_f32 v42, v34, v34
    v_add_f32 v25, v25, v35
    v_cvt_pk_bf16_f32 v43, v35, v35
    s_waitcnt vmcnt(0)
    v_and_b32 v4, v40, v16
    v_and_b32 v5, v40, v17
    v_and_b32 v6, v40, v18
    v_and_b32 v7, v40, v19
    s_nop 1
    v_mfma_f32_16x16x32_bf16 v[20:23], v[80:83], v[4:7], v[20:23]
    v_and_b32 v48, v41, v16
    v_and_b32 v49, v41, v17
    v_and_b32 v50, v41, v18
    v_and_b32 v51, v41, v19
    s_nop 1
    v_mfma_f32_16x16x32_bf16 v[20:23], v[84:87], v[48:51], v[20:23]
    v_and_b32 v4, v42, v16
    v_and_b32 v5, v42, v17
    v_and_b32 v6, v42, v18
    v_and_b32 v7, v42, v19
    s_nop 1
    v_mfma_f32_16x16x32_bf16 v[20:23], v[88:91], v[4:7], v[20:23]
    v_and_b32 v48, v43, v16
    v_and_b32 v49, v43, v17
    v_and_b32 v50, v43, v18
    v_and_b32 v51, v43, v19
    s_nop 1
    v_mfma_f32_16x16x32_bf16 v[20:23], v[92:95], v[48:51], v[20:23]
    v_add_u32 v52, 32, v52
    s_add_u32 s29, s26, s45
    s_and_b32 s29, s29, 2047
    s_bfe_u32 s31, s29, 0x20004
    s_lshl_b32 s31, s31, 9
    s_lshr_b32 s28, s29, 6
    s_lshl_b32 s28, s28, 4
    s_or_b32 s31, s31, s28
    s_and_b32 s29, s29, 15
    s_or_b32 s29, s29, s31
    s_lshl_b32 s29, s29, 12
    s_add_u32 s29, s29, s24
    s_cmp_lt_u32 s26, 2048
    s_cselect_b32 s80, s29, 0x10000000
    buffer_load_dword v60, v61, s[40:43], 0 offen
    buffer_load_dwordx4 v[64:67], v2, s[32:35], s80 offen offset:0 nt
    buffer_load_dwordx4 v[68:71], v2, s[32:35], s80 offen offset:1024 nt
    buffer_load_dwordx4 v[72:75], v2, s[32:35], s80 offen offset:2048 nt
    buffer_load_dwordx4 v[76:79], v2, s[32:35], s80 offen offset:3072 nt
    buffer_load_dwordx4 v[80:83], v2, s[36:39], s80 offen offset:0 nt
    buffer_load_dwordx4 v[84:87], v2, s[36:39], s80 offen offset:1024 nt
    buffer_load_dwordx4 v[88:91], v2, s[36:39], s80 offen offset:2048 nt
    buffer_load_dwordx4 v[92:95], v2, s[36:39], s80 offen offset:3072 nt
    s_sub_u32 s46, s46, 1
    s_cmp_lg_u32 s46, 0
    s_cbranch_scc1 L_sloop
L_loop:
    s_cmp_ge_u32 s80, 0x10000000
    s_cbranch_scc1 L_exit
    s_waitcnt vmcnt(4)
    v_readfirstlane_b32 s26, v52
    v_dot2_f32_bf16 v32, v64, v8, 0
    v_dot2_f32_bf16 v40, v64, v12, 0
    v_dot2_f32_bf16 v32, v65, v9, v32
    v_dot2_f32_bf16 v40, v65, v13, v40
    v_dot2_f32_bf16 v32, v66, v10, v32
    v_dot2_f32_bf16 v40, v66, v14, v40
    v_dot2_f32_bf16 v32, v67, v11, v32
    v_dot2_f32_bf16 v40, v67, v15, v40
    v_dot2_f32_bf16 v33, v68, v8, 0
    v_dot2_f32_bf16 v41, v68, v12, 0
    v_dot2_f32_bf16 v33, v69, v9, v33
    v_dot2_f32_bf16 v41, v69, v13, v41
    v_dot2_f32_bf16 v33, v70, v10, v33
    v_dot2_f32_bf16 v41, v70, v14, v41
    v_dot2_f32_bf16 v33, v71, v11, v33
    v_dot2_f32_bf16 v41, v71, v15, v41
    v_dot2_f32_bf16 v34, v72, v8, 0
    v_dot2_f32_bf16 v42, v72, v12, 0
    v_dot2_f32_bf16 v34, v73, v9, v34
    v_dot2_f32_bf16 v42, v73, v13, v42
    v_dot2_f32_bf16 v34, v74, v10, v34
    v_dot2_f32_bf16 v42, v74, v14, v42
    v_dot2_f32_bf16 v34, v75, v11, v34
    v_dot2_f32_bf16 v42, v75, v15, v42
    v_dot2_f32_bf16 v35, v76, v8, 0
    v_dot2_f32_bf16 v43, v76, v12, 0
    v_dot2_f32_bf16 v35, v77, v9, v35
    v_dot2_f32_bf16 v43, v77, v13, v43
    v_dot2_f32_bf16 v35, v78, v10, v35
    v_dot2_f32_bf16 v43, v78, v14, v43
    v_dot2_f32_bf16 v35, v79, v11, v35
    v_dot2_f32_bf16 v43, v79, v15, v43
    v_add_f32_dpp v32, v40, v32 row_ror:8 row_mask:0xf bank_mask:0xf
    v_add_f32_dpp v33, v41, v33 row_ror:8 row_mask:0xf bank_mask:0xf
    v_add_f32_dpp v34, v42, v34 row_ror:8 row_mask:0xf bank_mask:0xf
    v_add_f32_dpp v35, v43, v35 row_ror:8 row_mask:0xf bank_mask:0xf
    v_add_f32_dpp v32, v32, v32 row_half_mirror row_mask:0xf bank_mask:0xf
    v_add_f32_dpp v33, v33, v33 row_half_mirror row_mask:0xf bank_mask:0xf
    v_add_f32_dpp v34, v34, v34 row_half_mirror row_mask:0xf bank_mask:0xf
    v_add_f32_dpp v35, v35, v35 row_half_mirror row_mask:0xf bank_mask:0xf
    v_add_f32_dpp v32, v32, v32 quad_perm:[1,0,3,2] row_mask:0xf bank_mask:0xf
    v_add_f32_dpp v33, v33, v33 quad_perm:[1,0,3,2] row_mask:0xf bank_mask:0xf
    v_add_f32_dpp v34, v34, v34 quad_perm:[1,0,3,2] row_mask:0xf bank_mask:0xf
    v_add_f32_dpp v35, v35, v35 quad_perm:[1,0,3,2] row_mask:0xf bank_mask:0xf
    v_add_f32_dpp v32, v32, v32 quad_perm:[2,3,0,1] row_mask:0xf bank_mask:0xf
    v_add_f32_dpp v33, v33, v33 quad_perm:[2,3,0,1] row_mask:0xf bank_mask:0xf
    v_add_f32_dpp v34, v34, v34 quad_perm:[2,3,0,1] row_mask:0xf bank_mask:0xf
    v_add_f32_dpp v35, v35, v35 quad_perm:[2,3,0,1] row_mask:0xf bank_mask:0xf
    v_max3_f32 v26, v32, v33, v24
    v_max3_f32 v26, v34, v35, v26
    v_mov_b32 v27, v26
    s_nop 1
    v_permlane16_swap_b32 v26, v27
    v_max_f32 v26, v26, v27
    v_mov_b32 v27, v26
    s_nop 1
    v_permlane32_swap_b32 v26, v27
    v_max_f32 v26, v26, v27
    v_sub_f32 v27, v24, v26
    v_mul_f32 v27, s30, v27
    v_exp_f32 v29, v27
    v_mul_f32 v30, s30, v26
    v_mov_b32 v24, v26
    v_fma_f32 v32, v32, s30, -v30
    v_fma_f32 v33, v33, s30, -v30
    v_fma_f32 v34, v34, s30, -v30
    v_fma_f32 v35, v35, s30, -v30
    v_exp_f32 v32, v32
    v_exp_f32 v33, v33
    v_exp_f32 v34, v34
    v_exp_f32 v35, v35
    v_mul_f32 v20, v20, v29
    v_mul_f32 v21, v21, v29
    v_mul_f32 v22, v22, v29
    v_mul_f32 v23, v23, v29
    v_mul_f32 v25, v25, v29
    v_add_f32 v25, v25, v32
    v_cvt_pk_bf16_f32 v40, v32, v32
    v_add_f32 v25, v25, v33
    v_cvt_pk_bf16_f32 v41, v33, v33
    v_add_f32 v25, v25, v34
    v_cvt_pk_bf16_f32 v42, v34, v34
    v_add_f32 v25, v25, v35
    v_cvt_pk_bf16_f32 v43, v35, v35
    s_waitcnt vmcnt(0)
    v_and_b32 v4, v40, v16
    v_and_b32 v5, v40, v17
    v_and_b32 v6, v40, v18
    v_and_b32 v7, v40, v19
    s_nop 1
    v_mfma_f32_16x16x32_bf16 v[20:23], v[80:83], v[4:7], v[20:23]
    v_and_b32 v48, v41, v16
    v_and_b32 v49, v41, v17
    v_and_b32 v50, v41, v18
    v_and_b32 v51, v41, v19
    s_nop 1
    v_mfma_f32_16x16x32_bf16 v[20:23], v[84:87], v[48:51], v[20:23]
    v_and_b32 v4, v42, v16
    v_and_b32 v5, v42, v17
    v_and_b32 v6, v42, v18
    v_and_b32 v7, v42, v19
    s_nop 1
    v_mfma_f32_16x16x32_bf16 v[20:23], v[88:91], v[4:7], v[20:23]
    v_and_b32 v48, v43, v16
    v_and_b32 v49, v43, v17
    v_and_b32 v50, v43, v18
    v_and_b32 v51, v43, v19
    s_nop 1
    v_mfma_f32_16x16x32_bf16 v[20:23], v[92:95], v[48:51], v[20:23]
    v_mov_b32 v52, 1
    s_add_u32 s29, s26, s45
    s_and_b32 s29, s29, 2047
    s_bfe_u32 s31, s29, 0x20004
    s_lshl_b32 s31, s31, 9
    s_lshr_b32 s28, s29, 6
    s_lshl_b32 s28, s28, 4
    s_or_b32 s31, s31, s28
    s_and_b32 s29, s29, 15
    s_or_b32 s29, s29, s31
    s_lshl_b32 s29, s29, 12
    s_add_u32 s29, s29, s24
    s_cmp_lt_u32 s26, 2048
    s_cselect_b32 s80, s29, 0x10000000
    s_cbranch_scc0 L_exit
    buffer_atomic_add v52, v31, s[40:43], s44 offen sc0 sc1
    buffer_load_dwordx4 v[64:67], v2, s[32:35], s80 offen offset:0 nt
    buffer_load_dwordx4 v[68:71], v2, s[32:35], s80 offen offset:1024 nt
    buffer_load_dwordx4 v[72:75], v2, s[32:35], s80 offen offset:2048 nt
    buffer_load_dwordx4 v[76:79], v2, s[32:35], s80 offen offset:3072 nt
    buffer_load_dwordx4 v[80:83], v2, s[36:39], s80 offen offset:0 nt
    buffer_load_dwordx4 v[84:87], v2, s[36:39], s80 offen offset:1024 nt
    buffer_load_dwordx4 v[88:91], v2, s[36:39], s80 offen offset:2048 nt
    buffer_load_dwordx4 v[92:95], v2, s[36:39], s80 offen offset:3072 nt
    s_branch L_loop
L_exit:
    v_mov_b32 v27, v25
    s_nop 1
    v_permlane16_swap_b32 v25, v27
    v_add_f32 v25, v25, v27
    v_mov_b32 v27, v25
    s_nop 1
    v_permlane32_swap_b32 v25, v27
    v_add_f32 v25, v25, v27
    v_and_b32 v28, 7, v1
    v_lshlrev_b32 v28, 2, v28
    v_lshl_add_u32 v28, v62, 7, v28
    v_lshl_add_u32 v28, v63, 9, v28
    s_mul_i32 s29, s27, 1056
    v_add_u32 v28, s29, v28
    v_lshlrev_b32 v27, 3, v63
    v_add_u32 v27, s29, v27
    ds_write_b32 v28, v20 offset:2048
    ds_write_b32 v28, v21 offset:2080
    ds_write_b32 v28, v22 offset:2112
    ds_write_b32 v28, v23 offset:2144
    ds_write_b64 v27, v[24:25] offset:3072
    s_waitcnt lgkmcnt(0)
    s_barrier
    s_cmp_lt_u32 s25, 9
    s_cbranch_scc1 L_work
    s_endpgm
L_work:
    s_lshl_b32 s28, s21, 15
    s_lshl_b32 s29, s27, 13
    s_add_u32 s28, s28, s29
    s_add_u32 s80, s28, 1048576
    s_add_u32 s81, s80, 4096
    v_lshrrev_b32 v29, 5, v1
    v_lshlrev_b32 v29, 3, v29
    s_mov_b32 s31, 0x400000
    s_mov_b32 s28, 0xf
    s_mov_b32 s94, 0x01000100
    s_mov_b32 s95, 0x03020302
    v_cmp_gt_u32 s[92:93], 32, v1
    s_waitcnt vmcnt(0)
    s_nop 3
L_appoll:
    s_bitcmp1_b32 s28, 0
    s_cbranch_scc0 L_apskip0
    buffer_load_dwordx4 v[64:67], v2, s[40:43], s80 offen offset:0 sc1
    buffer_load_dwordx2 v[80:81], v29, s[40:43], s80 offen offset:1024 sc1
L_apskip0:
    s_bitcmp1_b32 s28, 1
    s_cbranch_scc0 L_apskip1
    buffer_load_dwordx4 v[68:71], v2, s[40:43], s80 offen offset:2048 sc1
    buffer_load_dwordx2 v[82:83], v29, s[40:43], s80 offen offset:3072 sc1
L_apskip1:
    s_bitcmp1_b32 s28, 2
    s_cbranch_scc0 L_apskip2
    buffer_load_dwordx4 v[72:75], v2, s[40:43], s81 offen offset:0 sc1
    buffer_load_dwordx2 v[84:85], v29, s[40:43], s81 offen offset:1024 sc1
L_apskip2:
    s_bitcmp1_b32 s28, 3
    s_cbranch_scc0 L_apskip3
    buffer_load_dwordx4 v[76:79], v2, s[40:43], s81 offen offset:2048 sc1
    buffer_load_dwordx2 v[86:87], v29, s[40:43], s81 offen offset:3072 sc1
L_apskip3:
    s_waitcnt vmcnt(0)
    v_max3_u32 v32, v64, v65, v66
    v_max3_u32 v33, v68, v69, v70
    v_max3_u32 v34, v72, v73, v74
    v_max3_u32 v35, v76, v77, v78
    v_max3_u32 v32, v67, v80, v32
    v_max3_u32 v33, v71, v82, v33
    v_max3_u32 v34, v75, v84, v34
    v_max3_u32 v35, v79, v86, v35
    v_max_u32 v32, v81, v32
    v_max_u32 v33, v83, v33
    v_max_u32 v34, v85, v34
    v_max_u32 v35, v87, v35
    v_max3_u32 v27, v32, v33, v34
    v_max_u32 v27, v35, v27
    v_cmp_eq_u32 vcc, -1, v27
    s_nop 1
    s_cmp_eq_u64 vcc, 0
    s_nop 1
    s_cbranch_scc1 L_apgo
    s_mov_b32 s28, 0
    v_cmp_eq_u32 vcc, -1, v32
    s_nop 1
    s_cmp_lg_u64 vcc, 0
    s_cselect_b32 s29, 1, 0
    s_or_b32 s28, s28, s29
    v_cmp_eq_u32 vcc, -1, v33
    s_nop 1
    s_cmp_lg_u64 vcc, 0
    s_cselect_b32 s29, 2, 0
    s_or_b32 s28, s28, s29
    v_cmp_eq_u32 vcc, -1, v34
    s_nop 1
    s_cmp_lg_u64 vcc, 0
    s_cselect_b32 s29, 4, 0
    s_or_b32 s28, s28, s29
    v_cmp_eq_u32 vcc, -1, v35
    s_nop 1
    s_cmp_lg_u64 vcc, 0
    s_cselect_b32 s29, 8, 0
    s_or_b32 s28, s28, s29
    s_sub_u32 s31, s31, 1
    s_cbranch_scc1 L_apgo
    s_branch L_appoll
L_apgo:
    v_max_f32 v24, v80, v82
    v_max3_f32 v24, v84, v86, v24
    v_sub_f32 v80, v80, v24
    v_sub_f32 v82, v82, v24
    v_sub_f32 v84, v84, v24
    v_sub_f32 v86, v86, v24
    v_mul_f32 v80, s30, v80
    v_mul_f32 v82, s30, v82
    v_mul_f32 v84, s30, v84
    v_mul_f32 v86, s30, v86
    v_exp_f32 v80, v80
    v_exp_f32 v82, v82
    v_exp_f32 v84, v84
    v_exp_f32 v86, v86
    v_mul_f32 v25, v80, v81
    v_mul_f32 v20, v80, v64
    v_mul_f32 v21, v80, v65
    v_mul_f32 v22, v80, v66
    v_mul_f32 v23, v80, v67
    v_fmac_f32 v25, v82, v83
    v_fmac_f32 v20, v82, v68
    v_fmac_f32 v21, v82, v69
    v_fmac_f32 v22, v82, v70
    v_fmac_f32 v23, v82, v71
    v_fmac_f32 v25, v84, v85
    v_fmac_f32 v20, v84, v72
    v_fmac_f32 v21, v84, v73
    v_fmac_f32 v22, v84, v74
    v_fmac_f32 v23, v84, v75
    v_fmac_f32 v25, v86, v87
    v_fmac_f32 v20, v86, v76
    v_fmac_f32 v21, v86, v77
    v_fmac_f32 v22, v86, v78
    v_fmac_f32 v23, v86, v79
    s_mul_i32 s29, s27, 1056
    v_add_u32 v27, s29, v2
    v_add_u32 v28, s29, v29
    ds_write_b128 v27, v[20:23] offset:8192
    ds_write_b64 v28, v[24:25] offset:9216
    v_mul_u32_u24 v63, 2112, v63
    v_lshl_add_u32 v62, v62, 3, v63
    s_lshl_b32 s29, s27, 8
    v_add_u32 v62, s29, v62
    s_lshr_b32 s29, s27, 1
    s_lshl_b32 s29, s29, 3
    v_add_u32 v63, s29, v63
    s_lshl_b32 s29, s27, 10
    v_add_u32 v27, s29, v2
    s_waitcnt lgkmcnt(0)
    s_barrier
    ds_read_b64 v[32:33], v63 offset:9216
    ds_read_b64 v[34:35], v63 offset:10272
    ds_read_b64 v[64:65], v62 offset:8192
    ds_read_b64 v[80:81], v62 offset:9248
    ds_read_b64 v[66:67], v62 offset:8224
    ds_read_b64 v[82:83], v62 offset:9280
    ds_read_b64 v[68:69], v62 offset:8256
    ds_read_b64 v[84:85], v62 offset:9312
    ds_read_b64 v[70:71], v62 offset:8288
    ds_read_b64 v[86:87], v62 offset:9344
    ds_read_b64 v[72:73], v62 offset:8320
    ds_read_b64 v[88:89], v62 offset:9376
    ds_read_b64 v[74:75], v62 offset:8352
    ds_read_b64 v[90:91], v62 offset:9408
    s_waitcnt lgkmcnt(8)
    ds_read_b64 v[76:77], v62 offset:8384
    ds_read_b64 v[92:93], v62 offset:9440
    ds_read_b64 v[78:79], v62 offset:8416
    ds_read_b64 v[94:95], v62 offset:9472
    v_max_f32 v24, v32, v34
    v_sub_f32 v32, v32, v24
    v_sub_f32 v34, v34, v24
    v_mul_f32 v32, s30, v32
    v_mul_f32 v34, s30, v34
    v_exp_f32 v32, v32
    v_exp_f32 v34, v34
    v_mul_f32 v25, v32, v33
    v_fmac_f32 v25, v34, v35
    v_rcp_f32 v25, v25
    s_nop 0
    v_mul_f32 v26, v32, v25
    v_mul_f32 v30, v34, v25
    s_waitcnt lgkmcnt(0)
    v_mul_f32 v64, v64, v26
    v_mul_f32 v65, v65, v26
    v_mul_f32 v66, v66, v26
    v_mul_f32 v67, v67, v26
    v_mul_f32 v68, v68, v26
    v_mul_f32 v69, v69, v26
    v_mul_f32 v70, v70, v26
    v_mul_f32 v71, v71, v26
    v_mul_f32 v72, v72, v26
    v_mul_f32 v73, v73, v26
    v_mul_f32 v74, v74, v26
    v_mul_f32 v75, v75, v26
    v_mul_f32 v76, v76, v26
    v_mul_f32 v77, v77, v26
    v_mul_f32 v78, v78, v26
    v_mul_f32 v79, v79, v26
    v_fmac_f32 v64, v80, v30
    v_fmac_f32 v65, v81, v30
    v_fmac_f32 v66, v82, v30
    v_fmac_f32 v67, v83, v30
    v_fmac_f32 v68, v84, v30
    v_fmac_f32 v69, v85, v30
    v_fmac_f32 v70, v86, v30
    v_fmac_f32 v71, v87, v30
    v_fmac_f32 v72, v88, v30
    v_fmac_f32 v73, v89, v30
    v_fmac_f32 v74, v90, v30
    v_fmac_f32 v75, v91, v30
    v_fmac_f32 v76, v92, v30
    v_fmac_f32 v77, v93, v30
    v_fmac_f32 v78, v94, v30
    v_fmac_f32 v79, v95, v30
    v_cvt_pk_bf16_f32 v80, v64, v65
    v_cvt_pk_bf16_f32 v81, v66, v67
    v_cvt_pk_bf16_f32 v82, v68, v69
    v_cvt_pk_bf16_f32 v83, v70, v71
    v_cvt_pk_bf16_f32 v84, v72, v73
    v_cvt_pk_bf16_f32 v85, v74, v75
    v_cvt_pk_bf16_f32 v86, v76, v77
    v_cvt_pk_bf16_f32 v87, v78, v79
    v_perm_b32 v14, v80, v80, s94
    v_and_b32 v4, v14, v16
    v_and_b32 v5, v14, v17
    v_and_b32 v6, v14, v18
    v_and_b32 v7, v14, v19
    v_perm_b32 v15, v80, v80, s95
    v_and_b32 v48, v15, v16
    v_and_b32 v49, v15, v17
    v_and_b32 v50, v15, v18
    v_and_b32 v51, v15, v19
    v_mfma_f32_16x16x32_bf16 v[20:23], v[96:99], v[4:7], 0
    v_perm_b32 v14, v81, v81, s94
    v_and_b32 v32, v14, v16
    v_and_b32 v33, v14, v17
    v_and_b32 v34, v14, v18
    v_and_b32 v35, v14, v19
    v_mfma_f32_16x16x32_bf16 v[56:59], v[96:99], v[48:51], 0
    v_perm_b32 v15, v81, v81, s95
    v_and_b32 v36, v15, v16
    v_and_b32 v37, v15, v17
    v_and_b32 v38, v15, v18
    v_and_b32 v39, v15, v19
    v_mfma_f32_16x16x32_bf16 v[20:23], v[100:103], v[32:35], v[20:23]
    v_perm_b32 v14, v82, v82, s94
    v_and_b32 v4, v14, v16
    v_and_b32 v5, v14, v17
    v_and_b32 v6, v14, v18
    v_and_b32 v7, v14, v19
    v_mfma_f32_16x16x32_bf16 v[56:59], v[100:103], v[36:39], v[56:59]
    v_perm_b32 v15, v82, v82, s95
    v_and_b32 v48, v15, v16
    v_and_b32 v49, v15, v17
    v_and_b32 v50, v15, v18
    v_and_b32 v51, v15, v19
    v_mfma_f32_16x16x32_bf16 v[20:23], v[104:107], v[4:7], v[20:23]
    v_perm_b32 v14, v83, v83, s94
    v_and_b32 v32, v14, v16
    v_and_b32 v33, v14, v17
    v_and_b32 v34, v14, v18
    v_and_b32 v35, v14, v19
    v_mfma_f32_16x16x32_bf16 v[56:59], v[104:107], v[48:51], v[56:59]
    v_perm_b32 v15, v83, v83, s95
    v_and_b32 v36, v15, v16
    v_and_b32 v37, v15, v17
    v_and_b32 v38, v15, v18
    v_and_b32 v39, v15, v19
    v_mfma_f32_16x16x32_bf16 v[20:23], v[108:111], v[32:35], v[20:23]
    v_perm_b32 v14, v84, v84, s94
    v_and_b32 v4, v14, v16
    v_and_b32 v5, v14, v17
    v_and_b32 v6, v14, v18
    v_and_b32 v7, v14, v19
    v_mfma_f32_16x16x32_bf16 v[56:59], v[108:111], v[36:39], v[56:59]
    v_perm_b32 v15, v84, v84, s95
    v_and_b32 v48, v15, v16
    v_and_b32 v49, v15, v17
    v_and_b32 v50, v15, v18
    v_and_b32 v51, v15, v19
    v_mfma_f32_16x16x32_bf16 v[20:23], v[112:115], v[4:7], v[20:23]
    v_perm_b32 v14, v85, v85, s94
    v_and_b32 v32, v14, v16
    v_and_b32 v33, v14, v17
    v_and_b32 v34, v14, v18
    v_and_b32 v35, v14, v19
    v_mfma_f32_16x16x32_bf16 v[56:59], v[112:115], v[48:51], v[56:59]
    v_perm_b32 v15, v85, v85, s95
    v_and_b32 v36, v15, v16
    v_and_b32 v37, v15, v17
    v_and_b32 v38, v15, v18
    v_and_b32 v39, v15, v19
    v_mfma_f32_16x16x32_bf16 v[20:23], v[116:119], v[32:35], v[20:23]
    v_perm_b32 v14, v86, v86, s94
    v_and_b32 v4, v14, v16
    v_and_b32 v5, v14, v17
    v_and_b32 v6, v14, v18
    v_and_b32 v7, v14, v19
    v_mfma_f32_16x16x32_bf16 v[56:59], v[116:119], v[36:39], v[56:59]
    v_perm_b32 v15, v86, v86, s95
    v_and_b32 v48, v15, v16
    v_and_b32 v49, v15, v17
    v_and_b32 v50, v15, v18
    v_and_b32 v51, v15, v19
    v_mfma_f32_16x16x32_bf16 v[20:23], v[120:123], v[4:7], v[20:23]
    v_perm_b32 v14, v87, v87, s94
    v_and_b32 v32, v14, v16
    v_and_b32 v33, v14, v17
    v_and_b32 v34, v14, v18
    v_and_b32 v35, v14, v19
    v_mfma_f32_16x16x32_bf16 v[56:59], v[120:123], v[48:51], v[56:59]
    v_perm_b32 v15, v87, v87, s95
    v_and_b32 v36, v15, v16
    v_and_b32 v37, v15, v17
    v_and_b32 v38, v15, v18
    v_and_b32 v39, v15, v19
    v_mfma_f32_16x16x32_bf16 v[20:23], v[124:127], v[32:35], v[20:23]
    s_nop 0
    v_mfma_f32_16x16x32_bf16 v[56:59], v[124:127], v[36:39], v[56:59]
    s_nop 7
    v_cndmask_b32 v20, v56, v20, s[92:93]
    v_cndmask_b32 v21, v57, v21, s[92:93]
    v_cndmask_b32 v22, v58, v22, s[92:93]
    v_cndmask_b32 v23, v59, v23, s[92:93]
    ds_write_b128 v27, v[20:23] offset:2048
    s_waitcnt lgkmcnt(0)
    s_barrier
    s_endpgm
L_helper:
    s_setprio 3
    v_lshrrev_b32 v62, 4, v1
    v_bfe_u32 v29, v1, 3, 1
    v_and_b32 v63, 7, v1
    v_lshl_add_u32 v27, v62, 1, v29
    v_lshlrev_b32 v27, 13, v27
    v_lshl_add_u32 v27, v63, 4, v27
    v_mul_u32_u24 v28, 1152, v29
    v_lshl_add_u32 v28, v62, 2, v28
    v_lshlrev_b32 v25, 10, v29
    v_lshl_add_u32 v25, v62, 7, v25
    v_lshl_add_u32 v25, v63, 4, v25
    v_mov_b32 v26, 0x40000000
    v_cmp_gt_u32 vcc, 32, v1
    s_nop 1
    v_cndmask_b32 v25, v26, v25, vcc
    s_and_b32 s25, s2, 15
    s_and_b32 s26, s2, 3
    s_bfe_u32 s27, s2, 0x20002
    s_mul_i32 s28, s27, 144
    s_lshl_b32 s29, s28, 13
    s_lshl_b32 s31, s21, 9
    s_add_u32 s29, s29, s31
    s_lshl_b32 s31, s26, 7
    s_add_u32 s29, s29, s31
    s_lshl_b32 s28, s28, 1
    s_lshl_b32 s91, s21, 13
    s_lshl_b32 s92, s27, 11
    s_add_u32 s92, s92, s91
    s_lshl_b32 s31, s26, 8
    s_add_u32 s92, s92, s31
    s_lshl_b32 s31, s22, 10
    s_add_u32 s91, s91, s31
    s_add_u32 s93, s91, 4096
    s_waitcnt lgkmcnt(0)
    s_mov_b32 s52, s10
    s_and_b32 s53, s11, 0xffff
    s_mov_b32 s54, 0x480000
    s_mov_b32 s55, 0x00020000
    s_mov_b32 s40, s18
    s_and_b32 s41, s19, 0xffff
    s_mov_b32 s42, 0x40000000
    s_mov_b32 s43, 0x00020000
    s_mov_b32 s48, s4
    s_and_b32 s49, s5, 0xffff
    s_mov_b32 s50, 0x900
    s_mov_b32 s51, 0x00020000
    buffer_load_dwordx4 v[32:35], v2, s[40:43], s91 offen offset:0 sc1
    buffer_load_dwordx4 v[36:39], v2, s[40:43], s91 offen offset:2048 sc1
    buffer_load_dwordx4 v[40:43], v2, s[40:43], s93 offen offset:0 sc1
    buffer_load_dwordx4 v[44:47], v2, s[40:43], s93 offen offset:2048 sc1
    buffer_load_dwordx4 v[52:55], v25, s[40:43], s92 offen offset:0 sc1
    buffer_load_dword v136, v28, s[48:51], s28 offen offset:0
    buffer_load_dword v137, v28, s[48:51], s28 offen offset:16
    buffer_load_dword v138, v28, s[48:51], s28 offen offset:32
    buffer_load_dword v139, v28, s[48:51], s28 offen offset:48
    buffer_load_dword v140, v28, s[48:51], s28 offen offset:64
    buffer_load_dword v141, v28, s[48:51], s28 offen offset:80
    buffer_load_dword v142, v28, s[48:51], s28 offen offset:96
    buffer_load_dword v143, v28, s[48:51], s28 offen offset:112
    buffer_load_dword v144, v28, s[48:51], s28 offen offset:128
    buffer_load_dword v145, v28, s[48:51], s28 offen offset:144
    buffer_load_dword v146, v28, s[48:51], s28 offen offset:160
    buffer_load_dword v147, v28, s[48:51], s28 offen offset:176
    buffer_load_dword v148, v28, s[48:51], s28 offen offset:192
    buffer_load_dword v149, v28, s[48:51], s28 offen offset:208
    buffer_load_dword v150, v28, s[48:51], s28 offen offset:224
    buffer_load_dword v151, v28, s[48:51], s28 offen offset:240
    buffer_load_dword v152, v28, s[48:51], s28 offen offset:256
    buffer_load_dword v153, v28, s[48:51], s28 offen offset:272
    buffer_load_dwordx4 v[64:67], v27, s[52:55], s29 offen nt
    s_add_u32 s29, s29, 0x10000
    buffer_load_dwordx4 v[68:71], v27, s[52:55], s29 offen nt
    s_add_u32 s29, s29, 0x10000
    buffer_load_dwordx4 v[72:75], v27, s[52:55], s29 offen nt
    s_add_u32 s29, s29, 0x10000
    buffer_load_dwordx4 v[76:79], v27, s[52:55], s29 offen nt
    s_add_u32 s29, s29, 0x10000
    buffer_load_dwordx4 v[80:83], v27, s[52:55], s29 offen nt
    s_add_u32 s29, s29, 0x10000
    buffer_load_dwordx4 v[84:87], v27, s[52:55], s29 offen nt
    s_add_u32 s29, s29, 0x10000
    buffer_load_dwordx4 v[88:91], v27, s[52:55], s29 offen nt
    s_add_u32 s29, s29, 0x10000
    buffer_load_dwordx4 v[92:95], v27, s[52:55], s29 offen nt
    s_add_u32 s29, s29, 0x10000
    buffer_load_dwordx4 v[96:99], v27, s[52:55], s29 offen nt
    s_add_u32 s29, s29, 0x10000
    buffer_load_dwordx4 v[100:103], v27, s[52:55], s29 offen nt
    s_add_u32 s29, s29, 0x10000
    buffer_load_dwordx4 v[104:107], v27, s[52:55], s29 offen nt
    s_add_u32 s29, s29, 0x10000
    buffer_load_dwordx4 v[108:111], v27, s[52:55], s29 offen nt
    s_add_u32 s29, s29, 0x10000
    buffer_load_dwordx4 v[112:115], v27, s[52:55], s29 offen nt
    s_add_u32 s29, s29, 0x10000
    buffer_load_dwordx4 v[116:119], v27, s[52:55], s29 offen nt
    s_add_u32 s29, s29, 0x10000
    buffer_load_dwordx4 v[120:123], v27, s[52:55], s29 offen nt
    s_add_u32 s29, s29, 0x10000
    buffer_load_dwordx4 v[124:127], v27, s[52:55], s29 offen nt
    s_add_u32 s29, s29, 0x10000
    buffer_load_dwordx4 v[128:131], v27, s[52:55], s29 offen nt
    s_add_u32 s29, s29, 0x10000
    buffer_load_dwordx4 v[132:135], v27, s[52:55], s29 offen nt
    s_add_u32 s29, s29, 0x10000
    s_mov_b32 s60, s14
    s_and_b32 s61, s15, 0xffff
    s_mov_b32 s62, 0x900
    s_mov_b32 s63, 0x00020000
    s_mov_b32 s64, s16
    s_and_b32 s65, s17, 0xffff
    s_mov_b32 s66, 0x100
    s_mov_b32 s67, 0x00020000
    v_mov_b32 v8, -1
    v_mov_b32 v9, -1
    v_mov_b32 v10, -1
    v_mov_b32 v11, -1
    v_lshlrev_b32 v26, 3, v1
    s_lshl_b32 s46, s2, 11
    s_add_u32 s46, s46, 1048576
    s_lshl_b32 s47, s25, 13
    s_lshl_b32 s31, s21, 9
    s_add_u32 s47, s47, s31
    s_add_u32 s47, s47, 2097152
    s_cmp_lt_u32 s25, 9
    s_cselect_b32 s47, s47, 0x40000000
    v_mov_b32 v3, 0x40000000
    v_cmp_gt_u32 vcc, 32, v1
    s_nop 1
    v_cndmask_b32 v3, v3, v2, vcc
    buffer_store_dwordx4 v[8:11], v2, s[40:43], s46 offen sc1
    v_and_b32 v61, 31, v1
    v_cmp_eq_u32 vcc, 0, v61
    v_lshrrev_b32 v26, 5, v1
    v_lshlrev_b32 v26, 3, v26
    v_mov_b32 v61, 0x40000000
    v_cndmask_b32 v61, v61, v26, vcc
    buffer_store_dwordx2 v[8:9], v61, s[40:43], s46 offen offset:1024 sc1
    buffer_store_dwordx4 v[8:11], v3, s[40:43], s47 offen sc1
    v_mov_b32 v12, 1856
    v_mov_b32 v13, 0x40000000
    s_cmp_eq_u32 s23, 0
    s_cselect_b64 vcc, -1, 0
    v_cndmask_b32 v13, v13, v31, vcc
    buffer_store_dword v12, v13, s[40:43], s44 offen sc1
    s_barrier
    s_mov_b32 s94, 0x01000100
    s_mov_b32 s95, 0x03020302
    s_waitcnt vmcnt(40)
    v_lshlrev_b32 v30, 31, v32
    v_alignbit_b32 v30, v33, v30, 1
    v_alignbit_b32 v30, v34, v30, 1
    v_alignbit_b32 v30, v35, v30, 1
    v_alignbit_b32 v30, v36, v30, 1
    v_alignbit_b32 v30, v37, v30, 1
    v_alignbit_b32 v30, v38, v30, 1
    v_alignbit_b32 v30, v39, v30, 1
    v_alignbit_b32 v30, v40, v30, 1
    v_alignbit_b32 v30, v41, v30, 1
    v_alignbit_b32 v30, v42, v30, 1
    v_alignbit_b32 v30, v43, v30, 1
    v_alignbit_b32 v30, v44, v30, 1
    v_alignbit_b32 v30, v45, v30, 1
    v_alignbit_b32 v30, v46, v30, 1
    v_alignbit_b32 v30, v47, v30, 1
    v_not_b32 v52, v52
    v_not_b32 v53, v53
    v_not_b32 v54, v54
    v_not_b32 v55, v55
    s_waitcnt vmcnt(22)
    v_perm_b32 v14, v136, v136, s94
    v_and_b32 v4, v14, v16
    v_and_b32 v5, v14, v17
    v_and_b32 v6, v14, v18
    v_and_b32 v7, v14, v19
    v_perm_b32 v15, v136, v136, s95
    v_and_b32 v48, v15, v16
    v_and_b32 v49, v15, v17
    v_and_b32 v50, v15, v18
    v_and_b32 v51, v15, v19
    s_waitcnt vmcnt(21)
    v_mfma_f32_16x16x32_bf16 v[20:23], v[64:67], v[4:7], 0
    v_mfma_f32_16x16x32_bf16 v[56:59], v[64:67], v[48:51], 0
    v_perm_b32 v14, v137, v137, s94
    v_and_b32 v4, v14, v16
    v_and_b32 v5, v14, v17
    v_and_b32 v6, v14, v18
    v_and_b32 v7, v14, v19
    v_perm_b32 v15, v137, v137, s95
    v_and_b32 v48, v15, v16
    v_and_b32 v49, v15, v17
    v_and_b32 v50, v15, v18
    v_and_b32 v51, v15, v19
    s_waitcnt vmcnt(20)
    v_mfma_f32_16x16x32_bf16 v[20:23], v[68:71], v[4:7], v[20:23]
    v_mfma_f32_16x16x32_bf16 v[56:59], v[68:71], v[48:51], v[56:59]
    v_perm_b32 v14, v138, v138, s94
    v_and_b32 v4, v14, v16
    v_and_b32 v5, v14, v17
    v_and_b32 v6, v14, v18
    v_and_b32 v7, v14, v19
    v_perm_b32 v15, v138, v138, s95
    v_and_b32 v48, v15, v16
    v_and_b32 v49, v15, v17
    v_and_b32 v50, v15, v18
    v_and_b32 v51, v15, v19
    s_waitcnt vmcnt(19)
    v_mfma_f32_16x16x32_bf16 v[20:23], v[72:75], v[4:7], v[20:23]
    v_mfma_f32_16x16x32_bf16 v[56:59], v[72:75], v[48:51], v[56:59]
    v_perm_b32 v14, v139, v139, s94
    v_and_b32 v4, v14, v16
    v_and_b32 v5, v14, v17
    v_and_b32 v6, v14, v18
    v_and_b32 v7, v14, v19
    v_perm_b32 v15, v139, v139, s95
    v_and_b32 v48, v15, v16
    v_and_b32 v49, v15, v17
    v_and_b32 v50, v15, v18
    v_and_b32 v51, v15, v19
    s_waitcnt vmcnt(18)
    v_mfma_f32_16x16x32_bf16 v[20:23], v[76:79], v[4:7], v[20:23]
    v_mfma_f32_16x16x32_bf16 v[56:59], v[76:79], v[48:51], v[56:59]
    v_perm_b32 v14, v140, v140, s94
    v_and_b32 v4, v14, v16
    v_and_b32 v5, v14, v17
    v_and_b32 v6, v14, v18
    v_and_b32 v7, v14, v19
    v_perm_b32 v15, v140, v140, s95
    v_and_b32 v48, v15, v16
    v_and_b32 v49, v15, v17
    v_and_b32 v50, v15, v18
    v_and_b32 v51, v15, v19
    s_waitcnt vmcnt(17)
    v_mfma_f32_16x16x32_bf16 v[20:23], v[80:83], v[4:7], v[20:23]
    v_mfma_f32_16x16x32_bf16 v[56:59], v[80:83], v[48:51], v[56:59]
    v_perm_b32 v14, v141, v141, s94
    v_and_b32 v4, v14, v16
    v_and_b32 v5, v14, v17
    v_and_b32 v6, v14, v18
    v_and_b32 v7, v14, v19
    v_perm_b32 v15, v141, v141, s95
    v_and_b32 v48, v15, v16
    v_and_b32 v49, v15, v17
    v_and_b32 v50, v15, v18
    v_and_b32 v51, v15, v19
    s_waitcnt vmcnt(16)
    v_mfma_f32_16x16x32_bf16 v[20:23], v[84:87], v[4:7], v[20:23]
    v_mfma_f32_16x16x32_bf16 v[56:59], v[84:87], v[48:51], v[56:59]
    v_perm_b32 v14, v142, v142, s94
    v_and_b32 v4, v14, v16
    v_and_b32 v5, v14, v17
    v_and_b32 v6, v14, v18
    v_and_b32 v7, v14, v19
    v_perm_b32 v15, v142, v142, s95
    v_and_b32 v48, v15, v16
    v_and_b32 v49, v15, v17
    v_and_b32 v50, v15, v18
    v_and_b32 v51, v15, v19
    s_waitcnt vmcnt(15)
    v_mfma_f32_16x16x32_bf16 v[20:23], v[88:91], v[4:7], v[20:23]
    v_mfma_f32_16x16x32_bf16 v[56:59], v[88:91], v[48:51], v[56:59]
    v_perm_b32 v14, v143, v143, s94
    v_and_b32 v4, v14, v16
    v_and_b32 v5, v14, v17
    v_and_b32 v6, v14, v18
    v_and_b32 v7, v14, v19
    v_perm_b32 v15, v143, v143, s95
    v_and_b32 v48, v15, v16
    v_and_b32 v49, v15, v17
    v_and_b32 v50, v15, v18
    v_and_b32 v51, v15, v19
    s_waitcnt vmcnt(14)
    v_mfma_f32_16x16x32_bf16 v[20:23], v[92:95], v[4:7], v[20:23]
    v_mfma_f32_16x16x32_bf16 v[56:59], v[92:95], v[48:51], v[56:59]
    v_perm_b32 v14, v144, v144, s94
    v_and_b32 v4, v14, v16
    v_and_b32 v5, v14, v17
    v_and_b32 v6, v14, v18
    v_and_b32 v7, v14, v19
    v_perm_b32 v15, v144, v144, s95
    v_and_b32 v48, v15, v16
    v_and_b32 v49, v15, v17
    v_and_b32 v50, v15, v18
    v_and_b32 v51, v15, v19
    s_waitcnt vmcnt(13)
    v_mfma_f32_16x16x32_bf16 v[20:23], v[96:99], v[4:7], v[20:23]
    v_mfma_f32_16x16x32_bf16 v[56:59], v[96:99], v[48:51], v[56:59]
    v_perm_b32 v14, v145, v145, s94
    v_and_b32 v4, v14, v16
    v_and_b32 v5, v14, v17
    v_and_b32 v6, v14, v18
    v_and_b32 v7, v14, v19
    v_perm_b32 v15, v145, v145, s95
    v_and_b32 v48, v15, v16
    v_and_b32 v49, v15, v17
    v_and_b32 v50, v15, v18
    v_and_b32 v51, v15, v19
    s_waitcnt vmcnt(12)
    v_mfma_f32_16x16x32_bf16 v[20:23], v[100:103], v[4:7], v[20:23]
    v_mfma_f32_16x16x32_bf16 v[56:59], v[100:103], v[48:51], v[56:59]
    v_perm_b32 v14, v146, v146, s94
    v_and_b32 v4, v14, v16
    v_and_b32 v5, v14, v17
    v_and_b32 v6, v14, v18
    v_and_b32 v7, v14, v19
    v_perm_b32 v15, v146, v146, s95
    v_and_b32 v48, v15, v16
    v_and_b32 v49, v15, v17
    v_and_b32 v50, v15, v18
    v_and_b32 v51, v15, v19
    s_waitcnt vmcnt(11)
    v_mfma_f32_16x16x32_bf16 v[20:23], v[104:107], v[4:7], v[20:23]
    v_mfma_f32_16x16x32_bf16 v[56:59], v[104:107], v[48:51], v[56:59]
    v_perm_b32 v14, v147, v147, s94
    v_and_b32 v4, v14, v16
    v_and_b32 v5, v14, v17
    v_and_b32 v6, v14, v18
    v_and_b32 v7, v14, v19
    v_perm_b32 v15, v147, v147, s95
    v_and_b32 v48, v15, v16
    v_and_b32 v49, v15, v17
    v_and_b32 v50, v15, v18
    v_and_b32 v51, v15, v19
    s_waitcnt vmcnt(10)
    v_mfma_f32_16x16x32_bf16 v[20:23], v[108:111], v[4:7], v[20:23]
    v_mfma_f32_16x16x32_bf16 v[56:59], v[108:111], v[48:51], v[56:59]
    v_perm_b32 v14, v148, v148, s94
    v_and_b32 v4, v14, v16
    v_and_b32 v5, v14, v17
    v_and_b32 v6, v14, v18
    v_and_b32 v7, v14, v19
    v_perm_b32 v15, v148, v148, s95
    v_and_b32 v48, v15, v16
    v_and_b32 v49, v15, v17
    v_and_b32 v50, v15, v18
    v_and_b32 v51, v15, v19
    s_waitcnt vmcnt(9)
    v_mfma_f32_16x16x32_bf16 v[20:23], v[112:115], v[4:7], v[20:23]
    v_mfma_f32_16x16x32_bf16 v[56:59], v[112:115], v[48:51], v[56:59]
    v_perm_b32 v14, v149, v149, s94
    v_and_b32 v4, v14, v16
    v_and_b32 v5, v14, v17
    v_and_b32 v6, v14, v18
    v_and_b32 v7, v14, v19
    v_perm_b32 v15, v149, v149, s95
    v_and_b32 v48, v15, v16
    v_and_b32 v49, v15, v17
    v_and_b32 v50, v15, v18
    v_and_b32 v51, v15, v19
    s_waitcnt vmcnt(8)
    v_mfma_f32_16x16x32_bf16 v[20:23], v[116:119], v[4:7], v[20:23]
    v_mfma_f32_16x16x32_bf16 v[56:59], v[116:119], v[48:51], v[56:59]
    v_perm_b32 v14, v150, v150, s94
    v_and_b32 v4, v14, v16
    v_and_b32 v5, v14, v17
    v_and_b32 v6, v14, v18
    v_and_b32 v7, v14, v19
    v_perm_b32 v15, v150, v150, s95
    v_and_b32 v48, v15, v16
    v_and_b32 v49, v15, v17
    v_and_b32 v50, v15, v18
    v_and_b32 v51, v15, v19
    s_waitcnt vmcnt(7)
    v_mfma_f32_16x16x32_bf16 v[20:23], v[120:123], v[4:7], v[20:23]
    v_mfma_f32_16x16x32_bf16 v[56:59], v[120:123], v[48:51], v[56:59]
    v_perm_b32 v14, v151, v151, s94
    v_and_b32 v4, v14, v16
    v_and_b32 v5, v14, v17
    v_and_b32 v6, v14, v18
    v_and_b32 v7, v14, v19
    v_perm_b32 v15, v151, v151, s95
    v_and_b32 v48, v15, v16
    v_and_b32 v49, v15, v17
    v_and_b32 v50, v15, v18
    v_and_b32 v51, v15, v19
    s_waitcnt vmcnt(6)
    v_mfma_f32_16x16x32_bf16 v[20:23], v[124:127], v[4:7], v[20:23]
    v_mfma_f32_16x16x32_bf16 v[56:59], v[124:127], v[48:51], v[56:59]
    v_perm_b32 v14, v152, v152, s94
    v_and_b32 v4, v14, v16
    v_and_b32 v5, v14, v17
    v_and_b32 v6, v14, v18
    v_and_b32 v7, v14, v19
    v_perm_b32 v15, v152, v152, s95
    v_and_b32 v48, v15, v16
    v_and_b32 v49, v15, v17
    v_and_b32 v50, v15, v18
    v_and_b32 v51, v15, v19
    s_waitcnt vmcnt(5)
    v_mfma_f32_16x16x32_bf16 v[20:23], v[128:131], v[4:7], v[20:23]
    v_mfma_f32_16x16x32_bf16 v[56:59], v[128:131], v[48:51], v[56:59]
    v_perm_b32 v14, v153, v153, s94
    v_and_b32 v4, v14, v16
    v_and_b32 v5, v14, v17
    v_and_b32 v6, v14, v18
    v_and_b32 v7, v14, v19
    v_perm_b32 v15, v153, v153, s95
    v_and_b32 v48, v15, v16
    v_and_b32 v49, v15, v17
    v_and_b32 v50, v15, v18
    v_and_b32 v51, v15, v19
    s_waitcnt vmcnt(4)
    v_mfma_f32_16x16x32_bf16 v[20:23], v[132:135], v[4:7], v[20:23]
    v_mfma_f32_16x16x32_bf16 v[56:59], v[132:135], v[48:51], v[56:59]
    s_nop 7
    v_permlane32_swap_b32 v56, v20
    v_permlane32_swap_b32 v57, v21
    v_permlane32_swap_b32 v58, v22
    v_permlane32_swap_b32 v59, v23
    v_mov_b32 v32, v56
    v_mov_b32 v33, v57
    v_mov_b32 v34, v58
    v_mov_b32 v35, v59
    v_permlane32_swap_b32 v32, v56
    v_permlane32_swap_b32 v33, v57
    v_permlane32_swap_b32 v34, v58
    v_permlane32_swap_b32 v35, v59
    v_add_f32 v20, v20, v56
    v_add_f32 v21, v21, v57
    v_add_f32 v22, v22, v58
    v_add_f32 v23, v23, v59
    v_bfi_b32 v20, 1, v52, v20
    v_bfi_b32 v21, 1, v53, v21
    v_bfi_b32 v22, 1, v54, v22
    v_bfi_b32 v23, 1, v55, v23
    v_lshlrev_b32 v24, 7, v62
    v_lshl_add_u32 v24, v29, 6, v24
    v_lshl_add_u32 v24, v63, 1, v24
    v_mov_b32 v12, 1
    s_lshl_b32 s28, s21, 4
    s_mov_b32 s31, 0x400000
    s_waitcnt vmcnt(0)
    buffer_store_dwordx4 v[20:23], v25, s[40:43], s92 offen offset:0 sc1
    buffer_load_dwordx4 v[32:35], v2, s[40:43], s91 offen offset:0 sc1
    buffer_load_dwordx4 v[36:39], v2, s[40:43], s91 offen offset:2048 sc1
    buffer_load_dwordx4 v[40:43], v2, s[40:43], s93 offen offset:0 sc1
    buffer_load_dwordx4 v[44:47], v2, s[40:43], s93 offen offset:2048 sc1
    s_waitcnt vmcnt(4)
    buffer_atomic_add v12, v31, s[64:67], s28 offen sc1
    s_mov_b32 s29, 0
    s_waitcnt vmcnt(1)
    s_branch L_qcheck
L_qpoll:
    s_and_b32 s26, s31, 3
    s_cmp_lg_u32 s26, 0
    s_cbranch_scc1 L_qnocnt
    buffer_load_dword v13, v31, s[64:67], s28 offen sc1
    s_waitcnt vmcnt(0)
    v_readfirstlane_b32 s29, v13
    s_nop 4
L_qnocnt:
    buffer_load_dwordx4 v[32:35], v2, s[40:43], s91 offen offset:0 sc1
    buffer_load_dwordx4 v[36:39], v2, s[40:43], s91 offen offset:2048 sc1
    buffer_load_dwordx4 v[40:43], v2, s[40:43], s93 offen offset:0 sc1
    buffer_load_dwordx4 v[44:47], v2, s[40:43], s93 offen offset:2048 sc1
    s_waitcnt vmcnt(0)
    s_cmp_ge_u32 s29, 16
    s_cbranch_scc1 L_qgo
L_qcheck:
    v_lshlrev_b32 v28, 31, v32
    v_alignbit_b32 v28, v33, v28, 1
    v_alignbit_b32 v28, v34, v28, 1
    v_alignbit_b32 v28, v35, v28, 1
    v_alignbit_b32 v28, v36, v28, 1
    v_alignbit_b32 v28, v37, v28, 1
    v_alignbit_b32 v28, v38, v28, 1
    v_alignbit_b32 v28, v39, v28, 1
    v_alignbit_b32 v28, v40, v28, 1
    v_alignbit_b32 v28, v41, v28, 1
    v_alignbit_b32 v28, v42, v28, 1
    v_alignbit_b32 v28, v43, v28, 1
    v_alignbit_b32 v28, v44, v28, 1
    v_alignbit_b32 v28, v45, v28, 1
    v_alignbit_b32 v28, v46, v28, 1
    v_alignbit_b32 v28, v47, v28, 1
    v_xor_b32 v28, v28, v30
    v_lshrrev_b32 v28, 16, v28
    v_cmp_ne_u32 vcc, 0xffff, v28
    s_sub_u32 s31, s31, 1
    s_nop 3
    s_cbranch_scc1 L_qgo
    s_cmp_lg_u64 vcc, 0
    s_cbranch_scc1 L_qpoll
L_qgo:
    v_and_b32 v32, -2, v32
    v_and_b32 v33, -2, v33
    v_and_b32 v34, -2, v34
    v_and_b32 v35, -2, v35
    v_and_b32 v36, -2, v36
    v_and_b32 v37, -2, v37
    v_and_b32 v38, -2, v38
    v_and_b32 v39, -2, v39
    v_and_b32 v40, -2, v40
    v_and_b32 v41, -2, v41
    v_and_b32 v42, -2, v42
    v_and_b32 v43, -2, v43
    v_and_b32 v44, -2, v44
    v_and_b32 v45, -2, v45
    v_and_b32 v46, -2, v46
    v_and_b32 v47, -2, v47
    v_add_f32 v32, v32, v36
    v_add_f32 v40, v40, v44
    v_add_f32 v33, v33, v37
    v_add_f32 v41, v41, v45
    v_add_f32 v34, v34, v38
    v_add_f32 v42, v42, v46
    v_add_f32 v35, v35, v39
    v_add_f32 v43, v43, v47
    v_add_f32 v32, v32, v40
    v_add_f32 v33, v33, v41
    v_add_f32 v34, v34, v42
    v_add_f32 v35, v35, v43
    v_cvt_pk_bf16_f32 v32, v32, v33
    v_cvt_pk_bf16_f32 v34, v34, v35
    ds_write_b16 v24, v32 offset:0
    ds_write_b16_d16_hi v24, v32 offset:16
    ds_write_b16 v24, v34 offset:32
    ds_write_b16_d16_hi v24, v34 offset:48
    s_waitcnt lgkmcnt(0)
    s_barrier
    s_cmp_lg_u32 s21, s25
    s_cbranch_scc1 L_nofin0
    s_cmp_ge_u32 s25, 9
    s_cbranch_scc1 L_nofin0
    v_lshlrev_b32 v28, 4, v1
    v_cmp_gt_u32 vcc, 16, v1
    s_nop 1
    v_cndmask_b32 v63, 16, 0, vcc
    s_nop 1
L_allpoll:
    buffer_load_dword v13, v28, s[64:67], 0 offen sc1
    s_waitcnt vmcnt(0)
    v_add_u32 v13, v13, v63
    v_cmp_gt_u32 vcc, 16, v13
    s_sub_u32 s31, s31, 1
    s_nop 3
    s_cbranch_scc1 L_nofin0
    s_sleep 8
    s_cmp_lg_u64 vcc, 0
    s_cbranch_scc1 L_allpoll
L_nofin0:
    s_lshl_b32 s27, s21, 15
    s_add_u32 s27, s27, 1048576
    s_add_u32 s80, s27, 0
    s_add_u32 s81, s27, 4096
    s_add_u32 s82, s27, 8192
    s_add_u32 s83, s27, 12288
    s_add_u32 s84, s27, 16384
    s_add_u32 s85, s27, 20480
    s_add_u32 s86, s27, 24576
    s_add_u32 s87, s27, 28672
    v_lshlrev_b32 v30, 3, v29
    v_lshlrev_b32 v27, 8, v29
    v_lshl_add_u32 v27, v62, 6, v27
    v_and_b32 v63, 7, v1
    v_lshl_add_u32 v27, v63, 1, v27
    v_mov_b32 v60, 0xfffffffe
    s_barrier
    ds_read_b128 v[64:67], v2 offset:2048
    ds_read_b64 v[80:81], v26 offset:3072
    ds_read_b128 v[68:71], v2 offset:3104
    ds_read_b64 v[82:83], v26 offset:4128
    ds_read_b128 v[72:75], v2 offset:4160
    ds_read_b64 v[84:85], v26 offset:5184
    ds_read_b128 v[76:79], v2 offset:5216
    ds_read_b64 v[86:87], v26 offset:6240
    s_waitcnt lgkmcnt(0)
    v_max_f32 v24, v80, v82
    v_max3_f32 v24, v84, v86, v24
    v_sub_f32 v80, v80, v24
    v_sub_f32 v82, v82, v24
    v_sub_f32 v84, v84, v24
    v_sub_f32 v86, v86, v24
    v_mul_f32 v80, s30, v80
    v_mul_f32 v82, s30, v82
    v_mul_f32 v84, s30, v84
    v_mul_f32 v86, s30, v86
    v_exp_f32 v80, v80
    v_exp_f32 v82, v82
    v_exp_f32 v84, v84
    v_exp_f32 v86, v86
    v_mul_f32 v25, v80, v81
    v_mul_f32 v20, v80, v64
    v_mul_f32 v21, v80, v65
    v_mul_f32 v22, v80, v66
    v_mul_f32 v23, v80, v67
    v_fmac_f32 v25, v82, v83
    v_fmac_f32 v20, v82, v68
    v_fmac_f32 v21, v82, v69
    v_fmac_f32 v22, v82, v70
    v_fmac_f32 v23, v82, v71
    v_fmac_f32 v25, v84, v85
    v_fmac_f32 v20, v84, v72
    v_fmac_f32 v21, v84, v73
    v_fmac_f32 v22, v84, v74
    v_fmac_f32 v23, v84, v75
    v_fmac_f32 v25, v86, v87
    v_fmac_f32 v20, v86, v76
    v_fmac_f32 v21, v86, v77
    v_fmac_f32 v22, v86, v78
    v_fmac_f32 v23, v86, v79
    v_min_u32 v20, v20, v60
    v_min_u32 v21, v21, v60
    v_min_u32 v22, v22, v60
    v_min_u32 v23, v23, v60
    v_min_u32 v24, v24, v60
    v_min_u32 v25, v25, v60
    buffer_store_dwordx4 v[20:23], v2, s[40:43], s46 offen sc1
    buffer_store_dwordx2 v[24:25], v61, s[40:43], s46 offen offset:1024 sc1
    s_cmp_lt_u32 s25, 9
    s_cbranch_scc1 L_hwork
    s_endpgm
L_hwork:
    s_barrier
    s_barrier
    ds_read_b128 v[64:67], v2 offset:2048
    ds_read_b128 v[68:71], v2 offset:3072
    ds_read_b128 v[72:75], v2 offset:4096
    ds_read_b128 v[76:79], v2 offset:5120
    s_waitcnt lgkmcnt(0)
    v_add_f32 v64, v64, v68
    v_add_f32 v65, v65, v69
    v_add_f32 v66, v66, v70
    v_add_f32 v67, v67, v71
    v_add_f32 v64, v64, v72
    v_add_f32 v65, v65, v73
    v_add_f32 v66, v66, v74
    v_add_f32 v67, v67, v75
    v_add_f32 v64, v64, v76
    v_add_f32 v65, v65, v77
    v_add_f32 v66, v66, v78
    v_add_f32 v67, v67, v79
    v_mov_b32 v68, v64
    v_mov_b32 v69, v65
    v_mov_b32 v70, v66
    v_mov_b32 v71, v67
    v_permlane32_swap_b32 v64, v68
    v_permlane32_swap_b32 v65, v69
    v_permlane32_swap_b32 v66, v70
    v_permlane32_swap_b32 v67, v71
    v_add_f32 v64, v64, v68
    v_add_f32 v65, v65, v69
    v_add_f32 v66, v66, v70
    v_add_f32 v67, v67, v71
    v_min_u32 v64, v64, v60
    v_min_u32 v65, v65, v60
    v_min_u32 v66, v66, v60
    v_min_u32 v67, v67, v60
    buffer_store_dwordx4 v[64:67], v3, s[40:43], s47 offen sc1
    s_cmp_eq_u32 s21, s25
    s_nop 0
    s_cbranch_scc1 L_final
    s_endpgm
L_final:
    v_mul_u32_u24 v28, 1152, v29
    v_lshl_add_u32 v28, v62, 6, v28
    v_lshl_add_u32 v28, v63, 1, v28
    v_mov_b32 v27, 0x40000000
    v_cmp_gt_u32 vcc, 32, v1
    s_nop 1
    v_cndmask_b32 v28, v27, v28, vcc
    s_lshl_b32 s26, s25, 7
    s_lshl_b32 s27, s25, 13
    s_add_u32 s27, s27, 2097152
    s_add_u32 s28, s27, 4096
L_oppoll:
    buffer_load_dwordx4 v[72:75], v2, s[40:43], s27 offen offset:0 sc1
    buffer_load_dwordx4 v[76:79], v2, s[40:43], s27 offen offset:1024 sc1
    buffer_load_dwordx4 v[80:83], v2, s[40:43], s27 offen offset:2048 sc1
    buffer_load_dwordx4 v[84:87], v2, s[40:43], s27 offen offset:3072 sc1
    buffer_load_dwordx4 v[88:91], v2, s[40:43], s28 offen offset:0 sc1
    buffer_load_dwordx4 v[92:95], v2, s[40:43], s28 offen offset:1024 sc1
    buffer_load_dwordx4 v[96:99], v2, s[40:43], s28 offen offset:2048 sc1
    buffer_load_dwordx4 v[100:103], v2, s[40:43], s28 offen offset:3072 sc1
    s_waitcnt vmcnt(0)
    v_max_u32 v27, v72, v73
    v_max3_u32 v27, v74, v75, v27
    v_max3_u32 v27, v76, v77, v27
    v_max3_u32 v27, v78, v79, v27
    v_max3_u32 v27, v80, v81, v27
    v_max3_u32 v27, v82, v83, v27
    v_max3_u32 v27, v84, v85, v27
    v_max3_u32 v27, v86, v87, v27
    v_max3_u32 v27, v88, v89, v27
    v_max3_u32 v27, v90, v91, v27
    v_max3_u32 v27, v92, v93, v27
    v_max3_u32 v27, v94, v95, v27
    v_max3_u32 v27, v96, v97, v27
    v_max3_u32 v27, v98, v99, v27
    v_max3_u32 v27, v100, v101, v27
    v_max3_u32 v27, v102, v103, v27
    v_cmp_eq_u32 vcc, -1, v27
    s_nop 1
    s_cmp_eq_u64 vcc, 0
    s_nop 1
    s_cbranch_scc1 L_opgo0
    s_sub_u32 s31, s31, 1
    s_cbranch_scc1 L_opgo0
    s_branch L_oppoll
L_opgo0:
    v_add_f32 v72, v72, v88
    v_add_f32 v73, v73, v89
    v_add_f32 v74, v74, v90
    v_add_f32 v75, v75, v91
    v_add_f32 v76, v76, v92
    v_add_f32 v77, v77, v93
    v_add_f32 v78, v78, v94
    v_add_f32 v79, v79, v95
    v_add_f32 v80, v80, v96
    v_add_f32 v81, v81, v97
    v_add_f32 v82, v82, v98
    v_add_f32 v83, v83, v99
    v_add_f32 v84, v84, v100
    v_add_f32 v85, v85, v101
    v_add_f32 v86, v86, v102
    v_add_f32 v87, v87, v103
    v_add_f32 v72, v72, v80
    v_add_f32 v73, v73, v81
    v_add_f32 v74, v74, v82
    v_add_f32 v75, v75, v83
    v_add_f32 v76, v76, v84
    v_add_f32 v77, v77, v85
    v_add_f32 v78, v78, v86
    v_add_f32 v79, v79, v87
    v_add_f32 v72, v72, v76
    v_add_f32 v73, v73, v77
    v_add_f32 v74, v74, v78
    v_add_f32 v75, v75, v79
    v_mov_b32 v64, v72
    v_mov_b32 v65, v73
    v_mov_b32 v66, v74
    v_mov_b32 v67, v75
    s_nop 1
L_opfin:
    v_mov_b32 v68, v64
    v_mov_b32 v69, v65
    v_mov_b32 v70, v66
    v_mov_b32 v71, v67
    v_permlane32_swap_b32 v64, v68
    v_permlane32_swap_b32 v65, v69
    v_permlane32_swap_b32 v66, v70
    v_permlane32_swap_b32 v67, v71
    v_add_f32 v64, v64, v68
    v_add_f32 v65, v65, v69
    v_add_f32 v66, v66, v70
    v_add_f32 v67, v67, v71
    v_cvt_pk_bf16_f32 v64, v64, v65
    v_cvt_pk_bf16_f32 v66, v66, v67
    buffer_store_short v64, v28, s[60:63], s26 offen
    buffer_store_short_d16_hi v64, v28, s[60:63], s26 offen offset:16
    buffer_store_short v66, v28, s[60:63], s26 offen offset:32
    buffer_store_short_d16_hi v66, v28, s[60:63], s26 offen offset:48
L_done:
    s_endpgm
.section .rodata,"a"
.p2align 6
.amdhsa_kernel standalone__gqa_block_cached__decode_kernel
  .amdhsa_next_free_vgpr 224
  .amdhsa_next_free_sgpr 100
  .amdhsa_accum_offset 224
  .amdhsa_group_segment_fixed_size 0
  .amdhsa_kernarg_size 64
  .amdhsa_user_sgpr_count 2
  .amdhsa_user_sgpr_kernarg_segment_ptr 1
  .amdhsa_system_sgpr_workgroup_id_x 1
.end_amdhsa_kernel
```
